```python
import torch

def _softmax(x, axis=-1):
    return torch.softmax(x, dim=axis)

def _gelu(x):
    return torch.nn.functional.gelu(x, approximate='tanh')

def _silu(x):
    return torch.nn.functional.silu(x)

def _sigmoid(x):
    return torch.sigmoid(x)

def _layernorm(x, axis=-1, eps=1e-05):
    m = x.mean(dim=axis, keepdim=True)
    v = x.var(dim=axis, keepdim=True, unbiased=False)
    return (x - m) / torch.sqrt(v + eps)

def _scatter_add(tgt, idx, src, axis=0):
    return tgt.clone().index_add_(axis, idx, src)

def _segment_sum(src, seg, n):
    out = torch.zeros((n,) + src.shape[1:], dtype=src.dtype)
    return out.index_add_(0, seg, src)

def _pad(x, pw):
    flat = tuple((v for pair in reversed(pw) for v in pair))
    return torch.nn.functional.pad(x, flat)
kernel_name = 'adaLN_cond__sliding_block_cached__geglu_ffn__decode'

def setup_inputs():

    _w = lambda a: (lambda t: t.to(torch.bfloat16) if t.is_floating_point() else t)(torch.as_tensor(a))

    def _A_setup():
        B, Sq, D = (1, 1, 448)
        Hq, Hkv, Sk, Dh = (16, 8, 8192, 256)
        assert Hq % Hkv == 0, (Hq, Hkv)
        return {'x': _w((lambda *s: torch.randn(*s, dtype=torch.bfloat16) * 0.05)(B, Sq, D)), 'k_cache': _w((lambda *s: torch.randn(*s, dtype=torch.bfloat16) * 3.2)(B, Hkv, Sk, Dh)), 'v_cache': _w((lambda *s: torch.randn(*s, dtype=torch.bfloat16) * 0.4)(B, Hkv, Sk, Dh)), 'wq': _w((lambda *s: torch.randn(*s, dtype=torch.bfloat16) * 3.2)(D, Hq * Dh) * D ** (-0.5)), 'wo': _w((lambda *s: torch.randn(*s, dtype=torch.bfloat16) * 0.4)(Hq * Dh, D) * (Hq * Dh) ** (-0.5))}
    _A_in = _A_setup()

    def _B_setup():
        B, S, D, F = (1, 1, 448, 1792)
        return {'x': _w((lambda *s: torch.randn(*s, dtype=torch.bfloat16) * 0.05)(B, S, D)), 'w_gate': _w((lambda *s: torch.randn(*s, dtype=torch.bfloat16) * 0.05)(D, F)), 'w_up': _w((lambda *s: torch.randn(*s, dtype=torch.bfloat16) * 0.05)(D, F)), 'w_down': _w((lambda *s: torch.randn(*s, dtype=torch.bfloat16) * 0.05)(F, D))}
    _B_in = _B_setup()
    return {'A_x': _A_in['x'], 'A_k_cache': _A_in['k_cache'], 'A_v_cache': _A_in['v_cache'], 'A_wq': _A_in['wq'], 'A_wo': _A_in['wo'], 'B_x': _B_in['x'], 'B_w_gate': _B_in['w_gate'], 'B_w_up': _B_in['w_up'], 'B_w_down': _B_in['w_down'], 'c': _w((lambda *s: torch.randn(*s, dtype=torch.bfloat16) * 0.2)(1, 448) * 8.0), 'w_mod': _w((lambda *s: torch.randn(*s, dtype=torch.bfloat16) * 0.2)(448, 6 * 448) * 448 ** (-0.5) * 8.0)}

def reference(A_x, A_k_cache, A_v_cache, A_wq, A_wo, B_x, B_w_gate, B_w_up, B_w_down, c, w_mod):

    def _A_ref(x, k_cache, v_cache, wq, wo):
        B, Sq, D = x.shape
        Hq, Dh = (16, 256)
        Hkv, Sk = (k_cache.shape[1], k_cache.shape[2])
        W = min(4096, max(256, Sk // 4))
        rep = Hq // Hkv
        q = (lambda x, *d: x.permute(*d))((x @ wq).reshape(B, Sq, Hq, Dh), 0, 2, 1, 3)
        k = (lambda x, n, axis: torch.repeat_interleave(x, n, dim=axis))(k_cache[:, :, Sk - W:, :], rep, axis=1)
        v = (lambda x, n, axis: torch.repeat_interleave(x, n, dim=axis))(v_cache[:, :, Sk - W:, :], rep, axis=1)
        scores = torch.einsum('bhqd,bhkd->bhqk', q, k) * Dh ** (-0.5)
        p = _softmax(scores, axis=-1)
        o = torch.einsum('bhqk,bhkd->bhqd', p, v)
        return (lambda x, *d: x.permute(*d))(o, 0, 2, 1, 3).reshape(B, Sq, Hq * Dh) @ wo

    def _B_ref(x, w_gate, w_up, w_down):
        return _gelu(x @ w_gate) * (x @ w_up) @ w_down
    x = A_x
    mod = (_silu(c) @ w_mod).reshape(c.shape[0], 6, 1, -1)
    sa, ca, ga, sb, cb, gb = (mod[:, 0].clone(), mod[:, 1].clone(), mod[:, 2].clone(), mod[:, 3].clone(), mod[:, 4].clone(), mod[:, 5].clone())
    h = _layernorm(x, axis=-1) * (1 + ca) + sa
    x = x + ga * _A_ref(h, A_k_cache, A_v_cache, A_wq, A_wo)
    h = _layernorm(x, axis=-1) * (1 + cb) + sb
    x = x + gb * _B_ref(h, B_w_gate, B_w_up, B_w_down)
    return x
```

```asm
; @launch grid=(248,1,1) block=(768,1,1) lds=135168
.amdgcn_target "amdgcn-amd-amdhsa--gfx950"
.text

.globl adaLN_cond__sliding_block_cached__geglu_ffn__decode_kernel
.p2align 8
.type adaLN_cond__sliding_block_cached__geglu_ffn__decode_kernel,@function
adaLN_cond__sliding_block_cached__geglu_ffn__decode_kernel:

  s_load_dwordx2 s[40:41], s[0:1], 24
  s_load_dwordx16 s[4:19], s[0:1], 0
  s_load_dwordx8 s[20:27], s[0:1], 64
  s_load_dwordx4 s[28:31], s[0:1], 96
  s_cmp_ge_u32 s2, 16
  s_cbranch_scc1 L_nopf
  s_getpc_b64 s[64:65]
L_pc:
  s_mov_b32 s3, (L_end-L_pc)/128+1
  v_cmp_gt_u32 vcc, s3, v0
  v_lshlrev_b32 v2, 7, v0
  v_mov_b32 v3, s65
  s_and_saveexec_b64 s[66:67], vcc
  s_cbranch_execz L_pfx
  v_add_co_u32 v2, vcc, s64, v2
  s_nop 1
  v_addc_co_u32 v3, vcc, 0, v3, vcc
  global_load_dword v126, v[2:3], off
L_pfx:
  s_mov_b64 exec, s[66:67]
L_nopf:
  s_cmp_ge_u32 s2, 248
  s_cbranch_scc1 L_end

  v_lshrrev_b32 v1, 6, v0
  v_and_b32 v0, 63, v0
  s_movk_i32 s37, 0xff
  v_readfirstlane_b32 s38, v1
  s_cmp_lt_u32 s2, 128
  s_cbranch_scc1 L_A
  s_cmp_ge_u32 s38, 8
  s_cbranch_scc1 L_end
  s_cmp_ge_u32 s2, 184
  s_cbranch_scc1 L_Q
  s_branch L_M
L_A:

  s_cmp_ge_u32 s38, 8
  s_cbranch_scc1 L_A_h2
  s_lshr_b32 s45, s2, 3
  s_and_b32 s44, s2, 7
  s_lshl3_add_u32 s56, s45, s38
  v_lshlrev_b32 v7, 4, v0
  s_and_b32 s47, s56, 63
  s_mul_i32 s47, s47, 57344
  s_lshr_b32 s3, s56, 6
  s_lshl3_add_u32 s3, s3, s44
  s_lshl_b32 s3, s3, 10
  s_add_u32 s52, s47, s3
  s_add_u32 s52, s52, 32768
  s_mov_b32 s42, 3670016
  s_mov_b32 s43, 0x20000

  v_lshrrev_b32 v10, 3, v0
  v_and_b32 v11, 7, v0
  s_add_u32 s53, s52, 4294926720
  s_add_u32 s3, s52, 16384
  s_cmp_lt_u32 s56, 64
  s_cselect_b32 s53, s3, s53
  s_cselect_b64 vcc, -1, 0
  v_lshlrev_b32 v6, 13, v10
  v_lshl_add_u32 v6, v11, 4, v6
  v_cndmask_b32 v6, v6, v7, vcc
  s_waitcnt lgkmcnt(0)
  buffer_load_dwordx4 v[96:99], v7, s[40:43], s52 offen
  buffer_load_dwordx4 v[96:99], v6, s[40:43], s53 offen
L_A_h2:

  v_lshrrev_b32 v10, 3, v0
  v_and_b32 v11, 7, v0
  s_and_b32 s44, s2, 7
  s_lshr_b32 s45, s2, 3
  v_lshrrev_b32 v29, 4, v0
  v_and_b32 v30, 15, v0
  s_lshl_b32 s46, s44, 22
  s_lshl_b32 s47, s45, 9
  s_add_u32 s46, s46, s47
  s_add_u32 s46, s46, 3145728
  s_cmp_ge_u32 s38, 8
  s_cbranch_scc1 L_V

  s_lshl_b32 s54, s44, 7
  s_lshl_b32 s3, s45, 3
  s_add_u32 s54, s54, s3
  s_add_u32 s54, s54, s38
  s_lshl_b32 s54, s54, 9
  s_add_u32 s54, s54, 2097152
  v_lshlrev_b32 v5, 6, v11
  v_xor_b32 v1, v11, v10
  v_lshlrev_b32 v1, 4, v1
  v_xor_b32 v2, 16, v1
  v_xor_b32 v28, 1, v10
  v_add_u32 v28, 8, v28
  s_lshl_b32 s47, s38, 17
  s_add_u32 s46, s46, s47
  s_lshl_b32 s47, s38, 13

  v_lshl_add_u32 v1, v10, 13, v1
  v_lshl_add_u32 v2, v28, 13, v2
  s_waitcnt lgkmcnt(0)
  s_load_dword s36, s[30:31], 0
  s_mov_b32 s32, s30
  s_mov_b32 s33, s31
  s_mov_b32 s34, 268435456
  s_mov_b32 s35, 0x20000
  buffer_load_dword v100, v5, s[32:35], s54 offen
  s_mov_b32 s48, s6
  s_mov_b32 s49, s7
  s_mov_b32 s50, 33554432
  s_mov_b32 s51, 0x20000
  s_add_u32 m0, s47, 0
  s_nop 0
  buffer_load_dwordx4 v1, s[48:51], s46 offen offset:0 nt lds
  s_add_u32 m0, s47, 896
  s_nop 0
  buffer_load_dwordx4 v1, s[48:51], s46 offen offset:128 nt lds
  s_add_u32 m0, s47, 1792
  s_nop 0
  buffer_load_dwordx4 v1, s[48:51], s46 offen offset:256 nt lds
  s_add_u32 m0, s47, 2688
  s_nop 0
  buffer_load_dwordx4 v1, s[48:51], s46 offen offset:384 nt lds
  s_add_u32 m0, s47, 4096
  s_nop 0
  buffer_load_dwordx4 v2, s[48:51], s46 offen offset:0 nt lds
  s_add_u32 m0, s47, 4992
  s_nop 0
  buffer_load_dwordx4 v2, s[48:51], s46 offen offset:128 nt lds

  s_lshl_b32 s15, s44, 15
  s_lshl_b32 s3, s38, 12
  s_add_u32 s15, s15, s3
  s_lshl_b32 s3, s45, 6
  s_add_u32 s15, s15, s3
  s_add_u32 s15, s15, 2621440
  s_lshl_b32 s55, s44, 9
  s_add_u32 s55, s55, 851968
  s_lshl_b32 s3, s44, 3
  s_add_u32 s3, s3, s38
  s_lshl_b32 s27, s3, 10
  s_add_u32 s27, s27, 196608
  s_lshl_b32 s3, s3, 13
  s_add_u32 s26, s3, 2097152
  s_lshl_b32 s3, s45, 4
  s_add_u32 s29, s55, s3
  s_add_u32 s28, s29, 4096
  s_lshl_b32 s44, s44, 1
  s_and_b32 s3, s45, 1
  s_lshl_b32 s21, s3, 8
  s_add_u32 s21, s21, s55
  s_add_u32 s3, s3, s44
  s_lshr_b32 s44, s45, 1
  s_mov_b32 s45, s3
  s_lshl_b32 s24, s45, 8
  s_lshl_b32 s3, s38, 5
  s_add_u32 s24, s24, s3
  s_mul_i32 s24, s24, 896
  s_lshl_b32 s3, s44, 7
  s_add_u32 s24, s24, s3

  s_lshl_b32 s20, s45, 14
  s_add_u32 s20, s20, 2621440
  s_lshl_b32 s3, s38, 11
  s_add_u32 s20, s20, s3
  s_mul_i32 s22, s45, 1792
  s_lshl_b32 s3, s44, 8
  s_add_u32 s22, s22, s3
  s_add_u32 s22, s22, 3276800
  s_lshl_b32 s3, s38, 15
  s_add_u32 s22, s22, s3
  s_mov_b32 s23, 0x3db8aa3b
  v_lshrrev_b32 v28, 3, v30
  v_and_b32 v16, 7, v30
  v_xor_b32 v4, v16, v28
  v_lshlrev_b32 v4, 7, v4
  v_lshl_add_u32 v4, v28, 12, v4
  v_xor_b32 v16, v16, v29
  v_lshl_add_u32 v4, v16, 4, v4
  v_add_u32 v128, s47, v4
  v_xor_b32 v129, 64, v128
  v_bfe_u32 v18, v0, 4, 1
  v_lshlrev_b32 v16, 1, v18
  v_xor_b32 v16, v16, v11
  v_lshlrev_b32 v16, 4, v16
  v_xor_b32 v17, 64, v16
  v_and_b32 v8, 1, v10
  v_lshl_add_u32 v8, v8, 4, v29
  v_mul_u32_u24 v8, 896, v8
  v_add_u32 v130, v8, v16
  v_add_u32 v131, v8, v17
  v_bfe_u32 v16, v0, 2, 2
  v_lshlrev_b32 v8, 7, v16
  v_lshl_add_u32 v8, v29, 10, v8
  v_lshl_add_u32 v8, v28, 5, v8
  v_lshl_add_u32 v8, v18, 6, v8
  v_and_b32 v19, 3, v0
  v_lshl_add_u32 v8, v19, 3, v8
  v_add_u32 v132, s47, v8
  v_xor_b32 v133, 32, v132
  v_xor_b32 v134, 64, v132
  v_xor_b32 v135, 96, v132
  v_bfe_u32 v9, v0, 2, 1
  v_mul_u32_u24 v9, 528, v9
  v_lshl_add_u32 v9, v29, 4, v9
  v_lshl_add_u32 v9, v19, 6, v9
  v_add_u32 v136, 131072, v9
  v_lshlrev_b32 v16, 6, v30
  v_lshl_add_u32 v137, v29, 4, v16
  v_lshlrev_b32 v145, 2, v0
  s_lshr_b32 s3, s38, 2
  s_lshl_b32 s3, s3, 4
  s_add_u32 s3, s3, 131072
  s_lshl_b32 s56, s38, 7
  s_add_u32 s3, s3, s56
  v_add_u32 v140, s3, v145
  s_lshl_b32 s3, s38, 2
  s_add_u32 s3, s3, 132160
  v_writelane_b32 v140, s3, 32
  v_mov_b32 v138, 1
  v_mov_b32 v149, 1
  v_mov_b32 v144, 132192
  v_lshlrev_b32 v16, 2, v11
  v_add_u32 v151, 132160, v16
  v_lshlrev_b32 v16, 2, v30
  v_add_u32 v141, 132224, v16
  s_lshl_b32 s3, s38, 3
  s_add_u32 s3, s3, 132224
  v_lshl_add_u32 v142, v18, 2, s3
  v_lshlrev_b32 v16, 1, v30
  v_lshl_add_u32 v16, v18, 5, v16
  s_lshl_b32 s3, s38, 6
  s_add_u32 s3, s3, 132352
  v_add_u32 v143, s3, v16
  v_and_b32 v16, 1, v0
  v_lshlrev_b32 v150, 8, v16
  s_lshl_b32 s3, s38, 8
  s_add_u32 s3, s3, 132864
  v_add_u32 v146, s3, v145
  v_add_u32 v147, 132864, v145
  v_lshl_add_u32 v16, v29, 2, v19
  v_lshlrev_b32 v148, 4, v16
  v_lshlrev_b32 v16, 4, v29
  v_add_u32 v148, 134912, v16
  v_lshlrev_b32 v16, 4, v30
  v_lshl_add_u32 v152, v29, 2, v16

  s_waitcnt lgkmcnt(0)
  s_mul_i32 s36, s36, 0x9E3779B1
  s_add_u32 s36, s36, 0x7F4A7C15
  v_bfe_u32 v19, v0, 2, 2

  v_lshlrev_b32 v19, 3, v19
  v_lshrrev_b32 v139, v19, s36

  s_add_u32 s56, s30, s15
  s_addc_u32 s57, s31, 0
  s_load_dword s101, s[56:57], 0
  s_load_dword s101, s[56:57], 1024
  s_load_dword s101, s[56:57], 2048
  s_load_dword s101, s[56:57], 3072
  s_lshl_b32 s3, s38, 6
  s_add_u32 s3, s3, s55
  s_add_u32 s56, s30, s3
  s_addc_u32 s57, s31, 0
  s_load_dword s101, s[56:57], 0

  s_waitcnt vmcnt(2)
  s_add_u32 m0, s47, 5888
  s_nop 0
  buffer_load_dwordx4 v2, s[48:51], s46 offen offset:256 nt lds
  s_add_u32 m0, s47, 6784
  s_nop 0
  buffer_load_dwordx4 v2, s[48:51], s46 offen offset:384 nt lds
  s_mov_b32 s40, s12
  s_mov_b32 s41, s13
  s_mov_b32 s42, 3670016
  s_mov_b32 s43, 0x20000
  s_mov_b32 s12, 0x11111111
  s_mov_b32 s13, s12
  s_barrier

  s_add_u32 s48, s30, s26
  s_addc_u32 s49, s31, 0
  s_mov_b32 s39, 0

  s_mul_i32 s25, s36, 10
  s_mov_b32 s46, 15

L_A_qpoll:
  s_load_dwordx16 s[52:67], s[48:49], 0

  s_load_dwordx16 s[68:83], s[48:49], 64
  s_load_dwordx16 s[84:99], s[48:49], 128
  s_add_u32 s48, s48, 256
  s_addc_u32 s49, s49, 0
  s_getreg_b32 s3, hwreg(HW_REG_IB_STS, 0, 4)
  s_xor_b32 s3, s3, 15
  s_cmp_eq_u32 s3, s46
  s_cbranch_scc1 L_A_krd
L_A_krb:
  s_add_u32 s39, s39, 1
  s_cmp_ge_u32 s39, 32
  s_cbranch_scc1 L_A_qslow
  s_waitcnt lgkmcnt(0)

  s_cmp_lg_u32 s95, s36
  s_cbranch_scc1 L_A_qpoll
  s_add_u32 s55, s55, s59
  s_add_u32 s63, s63, s67
  s_add_u32 s71, s71, s75
  s_add_u32 s79, s79, s83
  s_add_u32 s87, s87, s91
  s_add_u32 s55, s55, s63
  s_add_u32 s71, s71, s79
  s_add_u32 s55, s55, s87
  s_add_u32 s55, s55, s71
  s_cmp_lg_u32 s55, s25
  s_cbranch_scc1 L_A_qpoll
L_A_qgo:
  v_writelane_b32 v138, s52, 0
  v_writelane_b32 v138, s53, 1
  v_writelane_b32 v138, s54, 2
  v_writelane_b32 v138, s56, 3
  v_writelane_b32 v138, s57, 4
  v_writelane_b32 v138, s58, 5
  v_writelane_b32 v138, s60, 6
  v_writelane_b32 v138, s61, 7
  v_writelane_b32 v138, s62, 8
  v_writelane_b32 v138, s64, 9
  v_writelane_b32 v138, s65, 10
  v_writelane_b32 v138, s66, 11
  v_writelane_b32 v138, s68, 12
  v_writelane_b32 v138, s69, 13
  v_writelane_b32 v138, s70, 14
  v_writelane_b32 v138, s72, 15
  v_writelane_b32 v138, s73, 16
  v_writelane_b32 v138, s74, 17
  v_writelane_b32 v138, s76, 18
  v_writelane_b32 v138, s77, 19
  v_writelane_b32 v138, s78, 20
  v_writelane_b32 v138, s80, 21
  v_writelane_b32 v138, s81, 22
  v_writelane_b32 v138, s82, 23
  v_writelane_b32 v138, s84, 24
  v_writelane_b32 v138, s85, 25
  v_writelane_b32 v138, s86, 26
  v_writelane_b32 v138, s88, 27
  v_writelane_b32 v138, s89, 28
  v_writelane_b32 v138, s90, 29
  v_writelane_b32 v138, s92, 30
  v_writelane_b32 v138, s93, 31

  s_mov_b32 exec_hi, 1
  ds_write_b32 v140, v138
  s_mov_b32 exec_hi, -1

  s_cmp_eq_u32 s46, 15
  s_cbranch_scc0 L_A_qsp
  s_waitcnt vmcnt(0)
  ds_read_b128 v[32:35], v128 offset:0
  ds_read_b128 v[36:39], v129 offset:0
  ds_read_b128 v[40:43], v128 offset:1024
  ds_read_b128 v[44:47], v129 offset:1024
  ds_read_b128 v[48:51], v128 offset:2048
  ds_read_b128 v[52:55], v129 offset:2048
  ds_read_b128 v[56:59], v128 offset:3072
  ds_read_b128 v[60:63], v129 offset:3072

L_A_qsp:
  ds_read_b32 v9, v151
  ds_read_b128 v[96:99], v136
  ds_read_b128 v[100:103], v136 offset:256
  s_waitcnt lgkmcnt(2)
  v_cmp_ne_u32 vcc, 1, v9
  s_cbranch_vccnz L_A_qsp
  s_waitcnt lgkmcnt(1)
  v_mfma_f32_16x16x32_bf16 v[104:107], v[96:99], v[32:35], 0
  v_mfma_f32_16x16x32_bf16 v[108:111], v[96:99], v[36:39], 0
  v_mfma_f32_16x16x32_bf16 v[112:115], v[96:99], v[40:43], 0
  v_mfma_f32_16x16x32_bf16 v[116:119], v[96:99], v[44:47], 0
  s_waitcnt lgkmcnt(0)
  v_mfma_f32_16x16x32_bf16 v[104:107], v[100:103], v[48:51], v[104:107]
  v_mfma_f32_16x16x32_bf16 v[108:111], v[100:103], v[52:55], v[108:111]
  v_mfma_f32_16x16x32_bf16 v[112:115], v[100:103], v[56:59], v[112:115]
  v_mfma_f32_16x16x32_bf16 v[116:119], v[100:103], v[60:63], v[116:119]
  s_nop 5
  v_add_f32 v24, v104, v109
  s_nop 0
  v_add_f32 v25, v114, v119
  v_add_f32 v24, v24, v25

  v_cvt_pk_bf16_f32 v24, 0, v24
  s_nop 1
  v_max_f32_dpp v16, v24, v24 row_ror:8 row_mask:0xf bank_mask:0xf
  s_nop 1
  v_max_f32_dpp v16, v16, v16 row_ror:4 row_mask:0xf bank_mask:0xf
  s_nop 1
  v_max_f32_dpp v16, v16, v16 row_ror:2 row_mask:0xf bank_mask:0xf
  s_nop 1
  v_max_f32_dpp v16, v16, v16 row_ror:1 row_mask:0xf bank_mask:0xf
  v_mul_f32 v18, s23, v16
  v_fma_f32 v24, v24, s23, -v18
  v_exp_f32 v24, v24
  s_nop 0
  v_cvt_pk_bf16_f32 v25, v24, v24
  ds_write_b16 v143, v25
  s_mov_b64 exec, 0x10001
  ds_write_b32 v142, v18
  ds_add_u32 v144, v149
  s_mov_b64 exec, -1

  v_add_f32_dpp v19, v24, v24 row_ror:8 row_mask:0xf bank_mask:0xf
  s_nop 1
  v_add_f32_dpp v19, v19, v19 row_ror:4 row_mask:0xf bank_mask:0xf
  s_nop 1
  v_add_f32_dpp v19, v19, v19 row_ror:2 row_mask:0xf bank_mask:0xf
  s_nop 1
  v_add_f32_dpp v19, v19, v19 row_ror:1 row_mask:0xf bank_mask:0xf
  s_mov_b64 exec, 0x10001
  ds_write_b32 v142, v19 offset:64
  s_mov_b64 exec, 1
  ds_add_rtn_u32 v41, v144, v149 offset:4
  s_mov_b64 exec, -1
  s_waitcnt lgkmcnt(0)
  v_readfirstlane_b32 s3, v41
  s_mov_b32 s39, 0
  s_cmp_lg_u32 s3, 7
  s_cbranch_scc1 L_A_noml
  ds_read_b32 v32, v141
  ds_read_b32 v33, v141 offset:64
  s_waitcnt lgkmcnt(1)
  v_max_f32_dpp v48, v32, v32 row_ror:8 row_mask:0xf bank_mask:0xf
  s_nop 1
  v_max_f32_dpp v48, v48, v48 row_ror:4 row_mask:0xf bank_mask:0xf
  s_nop 1
  v_max_f32_dpp v48, v48, v48 row_ror:2 row_mask:0xf bank_mask:0xf
  v_sub_f32 v32, v32, v48
  v_exp_f32 v32, v32
  v_xor_b32 v50, s36, v48
  s_waitcnt lgkmcnt(0)
  v_mul_f32 v49, v32, v33
  s_nop 1
  v_add_f32_dpp v49, v49, v49 row_ror:8 row_mask:0xf bank_mask:0xf
  s_nop 1
  v_add_f32_dpp v49, v49, v49 row_ror:4 row_mask:0xf bank_mask:0xf
  s_nop 1
  v_add_f32_dpp v49, v49, v49 row_ror:2 row_mask:0xf bank_mask:0xf
  v_xor_b32 v51, s36, v49
  s_mov_b64 exec, 3
  buffer_store_dwordx4 v[48:51], v150, s[32:35], s29 offen
  buffer_store_dwordx4 v[48:51], v150, s[32:35], s28 offen sc1
  s_mov_b64 exec, -1
L_A_noml:
L_A_apf:

  s_and_b32 s44, s2, 7
  s_lshr_b32 s45, s2, 3
  s_load_dwordx2 s[52:53], s[0:1], 64
  s_mov_b32 s54, 1605632
  s_mov_b32 s55, 0x20000
  s_bitcmp1_b32 s45, 1
  s_cselect_b32 s48, s18, s16
  s_cselect_b32 s49, s19, s17
  s_mov_b32 s50, 1605632
  s_mov_b32 s51, 0x20000
  v_mul_u32_u24 v2, 3584, v10
  v_lshl_add_u32 v2, v11, 4, v2
  v_lshlrev_b32 v3, 4, v0

  s_lshr_b32 s3, s45, 2
  s_lshl_b32 s57, s3, 3
  s_add_u32 s57, s57, s44
  s_and_b32 s58, s44, 3
  s_add_u32 s58, s58, 24
  s_cmp_eq_u32 s3, 3
  s_cselect_b32 s57, s58, s57
  s_lshl_b32 s57, s57, 7

  s_and_b32 s3, s45, 1
  s_lshl_b32 s3, s3, 3
  s_add_u32 s3, s3, s38
  s_mul_i32 s3, s3, 100352
  s_add_u32 s60, s57, s3
  s_lshr_b32 s3, s45, 2
  s_lshl_b32 s3, s3, 4
  s_lshl_b32 s57, s44, 1
  s_add_u32 s57, s57, s3
  s_bfe_u32 s3, s45, 0x10001
  s_add_u32 s57, s57, s3
  s_and_b32 s3, s44, 3
  s_lshl_b32 s3, s3, 1
  s_lshr_b32 s58, s44, 2
  s_add_u32 s3, s3, s58
  s_add_u32 s3, s3, 48
  s_cmp_lt_u32 s45, 12
  s_cselect_b32 s57, s57, s3
  s_lshl_b32 s57, s57, 1
  s_and_b32 s3, s45, 1
  s_add_u32 s57, s57, s3
  s_lshl_b32 s57, s57, 3
  s_add_u32 s57, s57, s38
  s_mul_i32 s57, s57, 1792
  s_cmp_ge_u32 s45, 14
  s_cselect_b32 s61, 0x40000000, s57

L_A_vg4:
  ds_read_b32 v9, v144 offset:8
  s_waitcnt lgkmcnt(0)
  v_cmp_gt_u32 vcc, 4, v9
  s_cbranch_vccnz L_A_vg4
  buffer_load_dwordx4 v[80:83], v2, s[48:51], s60 offen
  s_add_u32 s60, s60, 0x7000
  buffer_load_dwordx4 v[80:83], v2, s[48:51], s60 offen
  s_add_u32 s60, s60, 0x7000
  buffer_load_dwordx4 v[80:83], v2, s[48:51], s60 offen
  s_add_u32 s60, s60, 0x3800
  buffer_load_dwordx4 v[80:83], v2, s[48:51], s60 offen
  buffer_load_dwordx4 v[80:83], v3, s[52:55], s61 offen
  buffer_load_dwordx4 v[80:83], v3, s[52:55], s61 offen offset:768
  s_waitcnt vmcnt(0)
L_A_fin:
  s_endpgm

L_A_qslow:
  s_add_u32 s48, s30, s27
  s_addc_u32 s49, s31, 0
L_A_qs:
  s_waitcnt lgkmcnt(0)
  s_load_dwordx16 s[52:67], s[48:49], 0 glc
  s_load_dwordx16 s[68:83], s[48:49], 64 glc
  s_load_dwordx16 s[84:99], s[48:49], 128 glc
  s_add_u32 s39, s39, 1
  s_cmp_ge_u32 s39, 20000
  s_waitcnt lgkmcnt(0)
  s_cbranch_scc1 L_A_qgo
  s_cmp_lg_u32 s95, s36
  s_cbranch_scc1 L_A_qs
  s_cmp_lg_u32 s91, s36
  s_cbranch_scc1 L_A_qs
  s_cmp_lg_u32 s87, s36
  s_cbranch_scc1 L_A_qs
  s_cmp_lg_u32 s83, s36
  s_cbranch_scc1 L_A_qs
  s_cmp_lg_u32 s79, s36
  s_cbranch_scc1 L_A_qs
  s_cmp_lg_u32 s75, s36
  s_cbranch_scc1 L_A_qs
  s_cmp_lg_u32 s71, s36
  s_cbranch_scc1 L_A_qs
  s_cmp_lg_u32 s67, s36
  s_cbranch_scc1 L_A_qs
  s_cmp_lg_u32 s63, s36
  s_cbranch_scc1 L_A_qs
  s_cmp_lg_u32 s59, s36
  s_cbranch_scc1 L_A_qs
  s_cmp_lg_u32 s55, s36
  s_cbranch_scc1 L_A_qs
  s_branch L_A_qgo
L_A_krd:
  s_waitcnt vmcnt(0)
  s_mov_b32 s46, 64
  ds_read_b128 v[32:35], v128 offset:0
  ds_read_b128 v[36:39], v129 offset:0
  ds_read_b128 v[40:43], v128 offset:1024
  ds_read_b128 v[44:47], v129 offset:1024
  ds_read_b128 v[48:51], v128 offset:2048
  ds_read_b128 v[52:55], v129 offset:2048
  ds_read_b128 v[56:59], v128 offset:3072
  ds_read_b128 v[60:63], v129 offset:3072
  s_branch L_A_krb
L_V:
  s_sub_u32 s47, s38, 8
  s_lshl_b32 s3, s47, 7
  s_add_u32 s46, s46, s3
  v_bfe_u32 v18, v0, 4, 1
  v_lshrrev_b32 v28, 3, v30
  v_lshlrev_b32 v16, 1, v18
  v_xor_b32 v16, v16, v11
  v_lshlrev_b32 v16, 4, v16
  v_xor_b32 v17, 64, v16
  v_add_u32 v20, 8, v10
  v_lshl_add_u32 v1, v10, 13, v16
  v_lshl_add_u32 v2, v20, 13, v17

  s_lshl_b32 s58, s44, 15
  s_lshl_b32 s3, s47, 12
  s_add_u32 s58, s58, s3
  s_lshl_b32 s3, s45, 6
  s_add_u32 s58, s58, s3
  s_add_u32 s58, s58, 2621440
  s_add_u32 s59, s58, 262144
  s_lshl_b32 s47, s47, 14
  s_add_u32 s47, s47, 65536
  v_bfe_u32 v16, v0, 2, 2
  v_lshlrev_b32 v8, 7, v16
  v_lshl_add_u32 v8, v29, 10, v8
  v_lshl_add_u32 v8, v28, 5, v8
  v_lshl_add_u32 v8, v18, 6, v8
  v_and_b32 v19, 3, v0
  v_lshl_add_u32 v8, v19, 3, v8
  v_add_u32 v4, s47, v8
  v_xor_b32 v5, 32, v4
  v_xor_b32 v6, 64, v4
  v_xor_b32 v7, 96, v4
  v_lshlrev_b32 v16, 5, v30
  v_lshl_add_u32 v16, v18, 4, v16
  v_add_u32 v8, 132352, v16
  v_lshlrev_b32 v16, 4, v29
  v_add_u32 v10, 132224, v16
  v_lshlrev_b32 v16, 2, v30
  v_add_u32 v11, 132224, v16
  v_lshl_add_u32 v16, v18, 14, v16
  v_lshrrev_b32 v17, 5, v0
  v_lshl_add_u32 v3, v17, 11, v16
  v_lshlrev_b32 v16, 14, v18
  v_lshl_add_u32 v16, v17, 11, v16
  v_and_b32 v20, 12, v0
  v_add_u32 v24, v16, v20
  s_lshl_b32 s3, s45, 6
  s_sub_u32 s56, s58, s3
  s_lshl_b32 s3, s45, 4
  s_add_u32 s56, s56, s3
  s_add_u32 s57, s56, 262144
  v_lshl_add_u32 v16, v29, 2, v19
  v_lshlrev_b32 v22, 4, v16
  v_lshlrev_b32 v16, 2, v16
  v_add_u32 v23, 134912, v16
  s_lshl_b32 s55, s44, 9
  s_and_b32 s3, s45, 1
  s_lshl_b32 s3, s3, 8
  s_add_u32 s55, s55, s3
  s_add_u32 s55, s55, 851968
  s_mov_b32 s76, 0x11111111
  s_mov_b32 s77, s76
  v_mov_b32 v21, -1
  ds_write_b32 v23, v21
  v_mov_b32 v21, 1
  v_mov_b32 v29, 132192

  v_mov_b32 v32, 0
  v_mov_b32 v33, 0
  v_mov_b32 v34, 0
  v_mov_b32 v35, 0
  v_mov_b32 v36, 0
  v_mov_b32 v37, 0
  v_mov_b32 v38, 0
  v_mov_b32 v39, 0
  v_mov_b32 v40, 0
  v_mov_b32 v41, 0
  v_mov_b32 v42, 0
  v_mov_b32 v43, 0
  v_mov_b32 v44, 0
  v_mov_b32 v45, 0
  v_mov_b32 v46, 0
  v_mov_b32 v47, 0
  s_mov_b32 s68, 0x30003
  s_mov_b32 s69, 0xc000c
  s_mov_b32 s70, 0x300030
  s_mov_b32 s71, 0xc000c0
  s_mov_b32 s72, 0x3000300
  s_mov_b32 s73, 0xc000c00
  s_mov_b32 s74, 0x30003000
  s_mov_b32 s75, 0xc000c000

  v_lshlrev_b32 v16, 2, v0
  v_add_u32 v16, 132160, v16
  s_mov_b64 exec, 0x7ff
  ds_write_b32 v16, v32
  s_mov_b64 exec, -1
  s_waitcnt lgkmcnt(0)
  s_load_dword s36, s[30:31], 0
  s_mov_b32 s32, s30
  s_mov_b32 s33, s31
  s_mov_b32 s34, 268435456
  s_mov_b32 s35, 0x20000
  s_mov_b32 s4, s8
  s_mov_b32 s5, s9
  s_mov_b32 s6, 33554432
  s_mov_b32 s7, 0x20000
  s_waitcnt lgkmcnt(0)
  s_mul_i32 s36, s36, 0x9E3779B1
  s_add_u32 s36, s36, 0x7F4A7C15
  s_barrier
  s_add_u32 m0, s47, 0
  s_nop 0
  buffer_load_dwordx4 v1, s[4:7], s46 offen nt lds
  s_add_u32 m0, s47, 1024
  s_nop 0
  buffer_load_dwordx4 v2, s[4:7], s46 offen nt lds
  s_add_u32 s46, s46, 0x20000
  s_add_u32 m0, s47, 2048
  s_nop 0
  buffer_load_dwordx4 v1, s[4:7], s46 offen nt lds
  s_add_u32 m0, s47, 3072
  s_nop 0
  buffer_load_dwordx4 v2, s[4:7], s46 offen nt lds
  s_add_u32 s46, s46, 0x20000
  s_add_u32 m0, s47, 4096
  s_nop 0
  buffer_load_dwordx4 v1, s[4:7], s46 offen nt lds
  s_add_u32 m0, s47, 5120
  s_nop 0
  buffer_load_dwordx4 v2, s[4:7], s46 offen nt lds
  s_add_u32 s46, s46, 0x20000
  s_add_u32 m0, s47, 6144
  s_nop 0
  buffer_load_dwordx4 v1, s[4:7], s46 offen nt lds
  s_add_u32 m0, s47, 7168
  s_nop 0
  buffer_load_dwordx4 v2, s[4:7], s46 offen nt lds
  s_add_u32 s46, s46, 0x20000
  s_add_u32 m0, s47, 8192
  s_nop 0
  buffer_load_dwordx4 v1, s[4:7], s46 offen nt lds
  s_add_u32 m0, s47, 9216
  s_nop 0
  buffer_load_dwordx4 v2, s[4:7], s46 offen nt lds
  s_add_u32 s46, s46, 0x20000
  s_add_u32 m0, s47, 10240
  s_nop 0
  buffer_load_dwordx4 v1, s[4:7], s46 offen nt lds
  s_add_u32 m0, s47, 11264
  s_nop 0
  buffer_load_dwordx4 v2, s[4:7], s46 offen nt lds
  s_add_u32 s46, s46, 0x20000
  s_add_u32 m0, s47, 12288
  s_nop 0
  buffer_load_dwordx4 v1, s[4:7], s46 offen nt lds
  s_add_u32 m0, s47, 13312
  s_nop 0
  buffer_load_dwordx4 v2, s[4:7], s46 offen nt lds
  s_add_u32 s46, s46, 0x20000
  s_add_u32 m0, s47, 14336
  s_nop 0
  buffer_load_dwordx4 v1, s[4:7], s46 offen nt lds
  s_add_u32 m0, s47, 15360
  s_nop 0
  buffer_load_dwordx4 v2, s[4:7], s46 offen nt lds
  s_waitcnt vmcnt(12)
  ds_read_b64_tr_b16 v[64:65], v4 offset:0
  ds_read_b64_tr_b16 v[66:67], v4 offset:512
  ds_read_b64_tr_b16 v[68:69], v5 offset:0
  ds_read_b64_tr_b16 v[70:71], v5 offset:512
  ds_read_b64_tr_b16 v[72:73], v6 offset:0
  ds_read_b64_tr_b16 v[74:75], v6 offset:512
  ds_read_b64_tr_b16 v[76:77], v7 offset:0
  ds_read_b64_tr_b16 v[78:79], v7 offset:512
  s_waitcnt vmcnt(8) lgkmcnt(0)
  ds_read_b64_tr_b16 v[80:81], v4 offset:4096
  ds_read_b64_tr_b16 v[82:83], v4 offset:4608
  ds_read_b64_tr_b16 v[84:85], v5 offset:4096
  ds_read_b64_tr_b16 v[86:87], v5 offset:4608
  ds_read_b64_tr_b16 v[88:89], v6 offset:4096
  ds_read_b64_tr_b16 v[90:91], v6 offset:4608
  ds_read_b64_tr_b16 v[92:93], v7 offset:4096
  ds_read_b64_tr_b16 v[94:95], v7 offset:4608
L_V_sp:
  ds_read_b32 v9, v29
  s_mov_b64 exec, s[68:69]
  ds_read_b128 v[32:35], v8
  s_mov_b64 exec, s[70:71]
  ds_read_b128 v[36:39], v8
  s_mov_b64 exec, s[72:73]
  ds_read_b128 v[40:43], v8
  s_mov_b64 exec, s[74:75]
  ds_read_b128 v[44:47], v8
  s_mov_b64 exec, -1
  ds_read_b32 v16, v11
  ds_read_b128 v[12:15], v10
  s_waitcnt lgkmcnt(6)
  v_cmp_ne_u32 vcc, 16, v9
  s_cbranch_vccnz L_V_sp
  s_waitcnt vmcnt(4) lgkmcnt(0)
  ds_read_b64_tr_b16 v[96:97], v4 offset:8192
  ds_read_b64_tr_b16 v[98:99], v4 offset:8704
  ds_read_b64_tr_b16 v[100:101], v5 offset:8192
  ds_read_b64_tr_b16 v[102:103], v5 offset:8704
  ds_read_b64_tr_b16 v[104:105], v6 offset:8192
  ds_read_b64_tr_b16 v[106:107], v6 offset:8704
  ds_read_b64_tr_b16 v[108:109], v7 offset:8192
  ds_read_b64_tr_b16 v[110:111], v7 offset:8704
  v_mfma_f32_16x16x32_bf16 v[48:51], v[32:35], v[64:67], 0
  v_max_f32_dpp v16, v16, v16 row_ror:8 row_mask:0xf bank_mask:0xf
  v_mfma_f32_16x16x32_bf16 v[52:55], v[32:35], v[68:71], 0
  s_nop 0
  v_max_f32_dpp v16, v16, v16 row_ror:4 row_mask:0xf bank_mask:0xf
  v_mfma_f32_16x16x32_bf16 v[56:59], v[32:35], v[72:75], 0
  s_nop 0
  v_max_f32_dpp v16, v16, v16 row_ror:2 row_mask:0xf bank_mask:0xf
  v_mfma_f32_16x16x32_bf16 v[60:63], v[32:35], v[76:79], 0
  s_nop 0
  v_subrev_f32_dpp v12, v16, v12 quad_perm:[0,0,0,0] row_mask:0xf bank_mask:0xf
  s_waitcnt vmcnt(0) lgkmcnt(4)
  ds_read_b64_tr_b16 v[112:113], v4 offset:12288
  ds_read_b64_tr_b16 v[114:115], v4 offset:12800
  ds_read_b64_tr_b16 v[116:117], v5 offset:12288
  ds_read_b64_tr_b16 v[118:119], v5 offset:12800
  ds_read_b64_tr_b16 v[120:121], v6 offset:12288
  ds_read_b64_tr_b16 v[122:123], v6 offset:12800
  ds_read_b64_tr_b16 v[124:125], v7 offset:12288
  ds_read_b64_tr_b16 v[126:127], v7 offset:12800
  v_mfma_f32_16x16x32_bf16 v[48:51], v[36:39], v[80:83], v[48:51]
  v_subrev_f32_dpp v13, v16, v13 quad_perm:[1,1,1,1] row_mask:0xf bank_mask:0xf
  v_mfma_f32_16x16x32_bf16 v[52:55], v[36:39], v[84:87], v[52:55]
  v_subrev_f32_dpp v14, v16, v14 quad_perm:[0,0,0,0] row_mask:0xf bank_mask:0xf
  v_mfma_f32_16x16x32_bf16 v[56:59], v[36:39], v[88:91], v[56:59]
  v_subrev_f32_dpp v15, v16, v15 quad_perm:[1,1,1,1] row_mask:0xf bank_mask:0xf
  v_mfma_f32_16x16x32_bf16 v[60:63], v[36:39], v[92:95], v[60:63]
  v_exp_f32 v12, v12
  s_waitcnt lgkmcnt(8)
  v_mfma_f32_16x16x32_bf16 v[48:51], v[40:43], v[96:99], v[48:51]
  v_exp_f32 v13, v13
  v_mfma_f32_16x16x32_bf16 v[52:55], v[40:43], v[100:103], v[52:55]
  v_exp_f32 v14, v14
  v_mfma_f32_16x16x32_bf16 v[56:59], v[40:43], v[104:107], v[56:59]
  v_exp_f32 v15, v15
  v_mfma_f32_16x16x32_bf16 v[60:63], v[40:43], v[108:111], v[60:63]
  s_waitcnt lgkmcnt(0)
  v_mfma_f32_16x16x32_bf16 v[48:51], v[44:47], v[112:115], v[48:51]
  v_mfma_f32_16x16x32_bf16 v[52:55], v[44:47], v[116:119], v[52:55]
  v_mfma_f32_16x16x32_bf16 v[56:59], v[44:47], v[120:123], v[56:59]
  v_mfma_f32_16x16x32_bf16 v[60:63], v[44:47], v[124:127], v[60:63]
  s_nop 4
  v_pk_mul_f32 v[48:49], v[48:49], v[12:13]
  v_pk_mul_f32 v[52:53], v[52:53], v[12:13]
  v_pk_mul_f32 v[56:57], v[56:57], v[12:13]
  v_pk_mul_f32 v[60:61], v[60:61], v[12:13]
  v_pk_fma_f32 v[48:49], v[50:51], v[14:15], v[48:49]
  v_pk_fma_f32 v[52:53], v[54:55], v[14:15], v[52:53]
  v_pk_fma_f32 v[56:57], v[58:59], v[14:15], v[56:57]
  v_pk_fma_f32 v[60:61], v[62:63], v[14:15], v[60:61]

  v_permlane16_swap_b32 v48, v49
  v_permlane16_swap_b32 v56, v57
  v_permlane16_swap_b32 v52, v53
  v_permlane16_swap_b32 v60, v61
  v_add_f32 v48, v48, v49
  v_add_f32 v56, v56, v57
  v_add_f32 v52, v52, v53
  v_add_f32 v60, v60, v61
  v_permlane32_swap_b32 v48, v56
  s_nop 0
  v_permlane32_swap_b32 v52, v60
  v_add_f32 v48, v48, v56
  v_add_f32 v52, v52, v60
  v_cvt_pk_bf16_f32 v26, v48, v52

  v_xor_b32 v27, s36, v26
  buffer_store_dword v26, v3, s[32:35], s58 offen
  buffer_store_dword v27, v3, s[32:35], s58 offen offset:1024
  s_mov_b64 exec, 1
  ds_add_u32 v29, v21 offset:8
  s_mov_b64 exec, -1

  buffer_store_dword v26, v3, s[32:35], s59 offen sc1
  buffer_store_dword v27, v3, s[32:35], s59 offen offset:1024 sc1
  s_endpgm
L_M:

  s_sub_u32 s44, s2, 128
  s_mul_i32 s45, s44, 37
  s_lshr_b32 s45, s45, 9
  s_mul_i32 s46, s45, 14
  s_sub_u32 s46, s44, s46
  s_mul_i32 s47, s45, 112
  s_lshl_b32 s3, s38, 4
  s_add_u32 s47, s47, s3
  v_lshrrev_b32 v29, 4, v0
  v_bfe_u32 v28, v0, 2, 1
  v_bfe_u32 v27, v0, 3, 1
  v_and_b32 v26, 7, v0
  v_lshlrev_b32 v1, 2, v29
  v_lshl_add_u32 v2, v28, 1, v1
  v_add_u32 v2, s47, v2
  v_lshlrev_b32 v2, 1, v2
  v_lshl_add_u32 v1, v27, 1, v1
  v_mul_u32_u24 v1, 5376, v1
  v_lshl_add_u32 v1, v26, 4, v1
  s_mul_i32 s52, s47, 5376
  s_lshl_b32 s3, s46, 7
  s_add_u32 s52, s52, s3
  s_add_u32 s53, s52, 5376

  s_waitcnt lgkmcnt(0)
  s_load_dword s36, s[30:31], 0
  s_mov_b32 s32, s30
  s_mov_b32 s33, s31
  s_mov_b32 s34, 268435456
  s_mov_b32 s35, 0x20000
  s_mov_b32 s40, s22
  s_mov_b32 s41, s23
  s_mov_b32 s42, 896
  s_mov_b32 s43, 0x20000
  s_mov_b32 s48, s24
  s_mov_b32 s49, s25
  s_mov_b32 s50, 2408448
  s_mov_b32 s51, 0x20000

  s_cmp_eq_u32 s38, 7
  s_cbranch_scc1 L_M_noload
  buffer_load_dword v16, v2, s[40:43], 0 offen
  buffer_load_dwordx4 v[32:35], v1, s[48:51], s52 offen nt
  buffer_load_dwordx4 v[36:39], v1, s[48:51], s53 offen nt
L_M_noload:

  s_mov_b32 s40, s4
  s_mov_b32 s41, s5
  s_mov_b32 s42, 896
  s_mov_b32 s43, 0x20000

  s_min_u32 s3, s38, 6
  s_lshl_b32 s3, s3, 6
  v_and_b32 v24, 15, v0
  v_lshl_add_u32 v24, v24, 2, v29
  v_add_u32 v24, s3, v24

  v_lshlrev_b32 v3, 1, v24
  buffer_load_ushort v25, v3, s[40:43], 0 offen
  v_lshlrev_b32 v23, 2, v24

  s_lshr_b32 s3, s44, 4
  s_lshl_b32 s3, s3, 4
  s_and_b32 s60, s44, 7
  s_lshl_b32 s60, s60, 1
  s_add_u32 s3, s3, s60
  s_bfe_u32 s60, s44, 0x10003
  s_add_u32 s3, s3, s60
  s_and_b32 s60, s44, 3
  s_lshl_b32 s60, s60, 1
  s_bfe_u32 s61, s44, 0x10002
  s_add_u32 s60, s60, s61
  s_add_u32 s60, s60, 48
  s_cmp_lt_u32 s44, 48
  s_cselect_b32 s54, s3, s60
  v_and_b32 v3, 1, v0
  v_mov_b32 v4, 0xffff
  v_lshlrev_b32 v3, 4, v3
  v_lshlrev_b32 v4, v3, v4
  v_bfe_u32 v3, v0, 3, 1
  v_lshlrev_b32 v3, 1, v3
  v_bfe_u32 v15, v0, 1, 1
  v_add_u32 v3, v3, v15
  v_cmp_eq_u32 vcc, 0, v3
  s_nop 1
  v_cndmask_b32 v12, 0, v4, vcc
  v_cmp_eq_u32 vcc, 1, v3
  s_nop 1
  v_cndmask_b32 v13, 0, v4, vcc
  v_cmp_eq_u32 vcc, 2, v3
  s_nop 1
  v_cndmask_b32 v14, 0, v4, vcc
  v_cmp_eq_u32 vcc, 3, v3
  s_nop 1
  v_cndmask_b32 v15, 0, v4, vcc
  v_and_b32 v10, 7, v0
  v_lshlrev_b32 v10, 5, v10
  v_lshrrev_b32 v3, 5, v0
  v_lshl_add_u32 v10, v3, 4, v10
  v_bfe_u32 v3, v0, 4, 1
  v_lshl_add_u32 v10, v3, 2, v10
  v_bfe_u32 v3, v0, 3, 1
  v_lshl_add_u32 v10, v3, 3, v10

  s_lshl_b32 s3, s38, 8
  v_add_u32 v10, s3, v10
  v_lshlrev_b32 v11, 2, v0

  s_waitcnt lgkmcnt(0)
  s_mul_i32 s36, s36, 0x9E3779B1
  s_add_u32 s36, s36, 0x7F4A7C15

  v_and_b32 v3, 3, v0
  v_lshlrev_b32 v3, 3, v3
  v_lshrrev_b32 v22, v3, s36
  v_and_b32 v3, 3, v24
  v_lshlrev_b32 v3, 3, v3
  v_lshrrev_b32 v21, v3, s36
  s_cmp_eq_u32 s38, 7
  s_cbranch_scc1 L_M_bar1
  s_waitcnt vmcnt(3)
  v_lshlrev_b32 v17, 16, v16
  v_and_b32 v18, 0xffff0000, v16

  v_mul_f32 v3, 0xbfb8aa3b, v17
  v_exp_f32 v3, v3
  s_nop 0
  v_add_f32 v3, 1.0, v3
  v_rcp_f32 v3, v3
  s_nop 0
  v_mul_f32 v3, v17, v3
  v_cvt_pk_bf16_f32 v17, v3, v3
  v_mul_f32 v4, 0xbfb8aa3b, v18
  v_exp_f32 v4, v4
  s_nop 0
  v_add_f32 v4, 1.0, v4
  v_rcp_f32 v4, v4
  s_nop 0
  v_mul_f32 v4, v18, v4
  v_cvt_pk_bf16_f32 v18, v4, v4
  v_and_b32 v40, v17, v12
  v_and_b32 v41, v17, v13
  v_and_b32 v42, v17, v14
  v_and_b32 v43, v17, v15
  v_and_b32 v44, v18, v12
  v_and_b32 v45, v18, v13
  v_and_b32 v46, v18, v14
  v_and_b32 v47, v18, v15
  s_waitcnt vmcnt(2)
  v_mfma_f32_16x16x32_bf16 v[4:7], v[40:43], v[32:35], 0
  s_waitcnt vmcnt(1)
  v_mfma_f32_16x16x32_bf16 v[4:7], v[44:47], v[36:39], v[4:7]
  s_nop 7
  v_permlane16_swap_b32 v4, v5
  v_permlane16_swap_b32 v6, v7
  s_nop 0
  v_add_f32_dpp v8, v5, v4 row_ror:8 row_mask:0xf bank_mask:0x3
  s_nop 1
  v_add_f32_dpp v8, v6, v7 row_ror:8 row_mask:0xf bank_mask:0xc
  ds_write_b32 v10, v8
  s_waitcnt lgkmcnt(0)
L_M_bar1:
  s_barrier
  ds_read2st64_b32 v[32:33], v11 offset0:0 offset1:1
  ds_read2st64_b32 v[34:35], v11 offset0:2 offset1:3
  ds_read2st64_b32 v[36:37], v11 offset0:4 offset1:5
  ds_read_b32 v38, v11 offset:1536

  s_mul_i32 s3, s45, 3584
  s_lshl_b32 s52, s46, 8
  s_add_u32 s3, s3, s52
  s_add_u32 s3, s3, 3145728
  s_lshl_b32 s52, s38, 14
  s_add_u32 s3, s3, s52
  s_waitcnt lgkmcnt(0)
  v_add_f32 v32, v32, v33
  v_add_f32 v34, v34, v35
  v_add_f32 v36, v36, v37
  v_add_f32 v32, v32, v34
  v_add_f32 v36, v36, v38
  v_add_f32 v32, v32, v36

  v_bfi_b32 v32, s37, v22, v32
  buffer_store_dword v32, v11, s[32:35], s3 offen sc1

L_M_dry0:

  s_cmp_ge_u32 s44, 28
  s_cselect_b32 s68, 1, 0
  s_mul_i32 s69, s68, 28
  s_sub_u32 s69, s44, s69
  s_mul_i32 s70, s68, 224
  s_lshl_b32 s3, s38, 5
  s_add_u32 s70, s70, s3
  v_lshlrev_b32 v125, 3, v29
  v_lshl_add_u32 v126, v28, 2, v125
  v_add_u32 v126, s70, v126
  v_lshlrev_b32 v126, 1, v126
  v_lshl_add_u32 v125, v27, 2, v125
  v_mul_u32_u24 v125, 5376, v125
  v_lshl_add_u32 v125, v26, 4, v125
  s_mul_i32 s70, s70, 5376
  s_lshl_b32 s3, s69, 7
  s_add_u32 s70, s70, s3
  s_add_u32 s70, s70, 1792
  s_cmp_eq_u32 s38, 7
  s_cselect_b32 s70, 0x40000000, s70
  s_mov_b32 s72, s22
  s_mov_b32 s73, s23
  s_mov_b32 s74, 896
  s_mov_b32 s75, 0x20000
  buffer_load_dwordx2 v[112:113], v126, s[72:75], 0 offen
  buffer_load_dwordx4 v[64:67], v125, s[48:51], s70 offen nt
  s_add_u32 s70, s70, 5376
  buffer_load_dwordx4 v[68:71], v125, s[48:51], s70 offen nt
  s_add_u32 s70, s70, 5376
  buffer_load_dwordx4 v[72:75], v125, s[48:51], s70 offen nt
  s_add_u32 s70, s70, 5376
  buffer_load_dwordx4 v[76:79], v125, s[48:51], s70 offen nt
  s_mov_b32 s64, s20
  s_mov_b32 s65, s21
  s_mov_b32 s66, 1605632
  s_mov_b32 s67, 0x20000

  s_and_b32 s60, s38, 1
  s_cselect_b32 s96, s18, s16
  s_cselect_b32 s97, s19, s17
  s_mov_b32 s98, 1605632
  s_mov_b32 s99, 0x20000
  s_lshr_b32 s3, s38, 1
  s_mul_i32 s63, s3, 401408
  s_lshl_b32 s61, s54, 6
  s_add_u32 s63, s63, s61
  s_mul_i32 s3, s3, 7168
  s_mul_i32 s61, s60, 28672
  s_add_u32 s3, s3, s61
  s_add_u32 s80, s3, 45056
  s_mul_i32 s62, s54, 28672
  s_lshl_b32 s3, s38, 7
  s_add_u32 s62, s62, s3
  s_lshl_b32 s81, s38, 12
  s_add_u32 s81, s81, 16384
  v_and_b32 v3, 3, v0
  v_lshrrev_b32 v2, 5, v0
  v_lshlrev_b32 v2, 1, v2
  v_xor_b32 v2, v2, v3
  v_xor_b32 v2, s60, v2
  v_lshrrev_b32 v8, 2, v0
  v_mul_u32_u24 v8, 3584, v8
  v_lshl_add_u32 v160, v2, 4, v8
  v_and_b32 v30, 1, v29
  v_lshlrev_b32 v2, 1, v30
  v_xor_b32 v2, v2, v26
  v_lshrrev_b32 v8, 3, v0
  v_mul_u32_u24 v8, 896, v8
  v_lshl_add_u32 v161, v2, 4, v8
  v_xor_b32 v162, 64, v161
  v_bfe_u32 v8, v0, 2, 2
  v_lshlrev_b32 v164, 7, v8
  v_lshl_add_u32 v164, v29, 10, v164
  v_lshl_add_u32 v164, v27, 5, v164
  v_lshl_add_u32 v164, v30, 6, v164
  v_lshl_add_u32 v164, v3, 3, v164
  v_add_u32 v164, s81, v164
  v_xor_b32 v165, 32, v164
  v_xor_b32 v166, 64, v164
  v_xor_b32 v167, 96, v164
  v_lshrrev_b32 v2, 1, v3
  v_mul_u32_u24 v163, 28672, v2
  v_lshl_add_u32 v163, v29, 9, v163
  v_lshl_add_u32 v163, v8, 6, v163
  s_and_b32 s3, s38, 3
  v_lshlrev_b32 v4, 1, v30
  v_xor_b32 v2, v2, v4
  v_xor_b32 v2, s3, v2
  v_lshl_add_u32 v163, v2, 4, v163
  v_and_b32 v2, 1, v0
  v_lshl_add_u32 v163, v2, 3, v163
  v_add_u32 v163, 45056, v163
  v_mul_u32_u24 v6, 1056, v8
  v_lshl_add_u32 v6, v3, 6, v6
  v_lshl_add_u32 v6, v29, 4, v6
  v_add_u32 v6, 8192, v6
  v_lshlrev_b32 v5, 1, v24
  v_add_u32 v5, 8192, v5
  v_add_u32 v4, 2176, v23
  v_add_u32 v7, 2176, v11
  v_and_b32 v8, 15, v0
  s_lshl_b32 s3, s3, 4
  s_add_u32 s3, s3, 12544
  v_lshl_add_u32 v24, v8, 1, s3
  v_lshlrev_b32 v26, 4, v29
  v_add_u32 v26, 12544, v26
  v_mul_u32_u24 v27, 1792, v29
  v_lshl_add_u32 v27, v8, 4, v27
  s_and_b32 s60, s44, 7
  s_lshl_b32 s60, s60, 15
  s_min_u32 s3, s38, 6
  s_lshl_b32 s3, s3, 8
  s_add_u32 s60, s60, s3
  s_add_u32 s60, s60, 3276800
  s_add_u32 s82, s60, 7168
  v_lshrrev_b32 v1, 1, v29
  v_lshl_add_u32 v1, v8, 1, v1
  v_mul_u32_u24 v1, 1792, v1
  v_lshl_add_u32 v1, v30, 4, v1
  s_mul_i32 s83, s38, 14336
  s_lshl_b32 s3, s44, 5
  s_add_u32 s83, s83, s3
  s_add_u32 s83, s83, 81920
  s_lshl_b32 s3, s44, 1
  v_add_u32 v8, s3, v30
  v_and_b32 v8, 3, v8
  v_lshlrev_b32 v8, 3, v8
  v_lshrrev_b32 v17, v8, s36
  v_xor_b32 v8, 16, v8
  v_lshrrev_b32 v28, v8, s36
  v_and_b32 v8, 1, v0
  v_lshl_add_u32 v19, v8, 2, v29
  s_lshl_b32 s3, s44, 3
  v_add_u32 v19, s3, v19
  v_lshlrev_b32 v20, 2, v19
  s_mul_i32 s61, s44, 1792
  s_add_u32 s61, s61, 81920
  s_mov_b32 s84, 0x00010001
  s_mov_b32 s85, s84
  s_lshl_b64 s[86:87], s[84:85], 1
  s_lshl_b64 s[88:89], s[84:85], 2
  s_lshl_b64 s[90:91], s[84:85], 3
  s_mov_b32 s92, 0x000f000f
  s_mov_b32 s93, s92

  s_mov_b32 s76, s12
  s_mov_b32 s77, s13
  s_mov_b32 s78, 3670016
  s_mov_b32 s79, 0x20000

  s_and_b32 s57, s44, 7
  s_mul_i32 s57, s57, 458752
  s_and_b32 s3, s44, 0x38
  s_add_u32 s3, s3, s38
  s_mul_i32 s3, s3, 4096
  s_add_u32 s57, s57, s3
  s_add_u32 s57, s57, 229376
  v_lshlrev_b32 v121, 4, v0
  buffer_load_dwordx4 v[144:147], v121, s[76:79], s57 offen offset:0
  buffer_load_dwordx4 v[144:147], v121, s[76:79], s57 offen offset:1024
  buffer_load_dwordx4 v[144:147], v121, s[76:79], s57 offen offset:2048
  buffer_load_dwordx4 v[144:147], v121, s[76:79], s57 offen offset:3072
  s_add_u32 s57, s57, 4096
  s_waitcnt vmcnt(8)

  v_lshlrev_b32 v114, 16, v112
  v_and_b32 v115, 0xffff0000, v112
  v_lshlrev_b32 v116, 16, v113
  v_and_b32 v117, 0xffff0000, v113
  v_mul_f32 v9, 0xbfb8aa3b, v114
  v_exp_f32 v9, v9
  s_nop 0
  v_add_f32 v9, 1.0, v9
  v_rcp_f32 v9, v9
  s_nop 0
  v_mul_f32 v9, v114, v9
  v_cvt_pk_bf16_f32 v114, v9, v9
  v_and_b32 v80, v114, v12
  v_and_b32 v81, v114, v13
  v_and_b32 v82, v114, v14
  v_and_b32 v83, v114, v15
  v_mul_f32 v9, 0xbfb8aa3b, v115
  v_exp_f32 v9, v9
  s_nop 0
  v_add_f32 v9, 1.0, v9
  v_rcp_f32 v9, v9
  s_nop 0
  v_mul_f32 v9, v115, v9
  v_cvt_pk_bf16_f32 v115, v9, v9
  v_and_b32 v84, v115, v12
  v_and_b32 v85, v115, v13
  v_and_b32 v86, v115, v14
  v_and_b32 v87, v115, v15
  v_mul_f32 v9, 0xbfb8aa3b, v116
  v_exp_f32 v9, v9
  s_nop 0
  v_add_f32 v9, 1.0, v9
  v_rcp_f32 v9, v9
  s_nop 0
  v_mul_f32 v9, v116, v9
  v_cvt_pk_bf16_f32 v116, v9, v9
  v_and_b32 v88, v116, v12
  v_and_b32 v89, v116, v13
  v_and_b32 v90, v116, v14
  v_and_b32 v91, v116, v15
  v_mul_f32 v9, 0xbfb8aa3b, v117
  v_exp_f32 v9, v9
  s_nop 0
  v_add_f32 v9, 1.0, v9
  v_rcp_f32 v9, v9
  s_nop 0
  v_mul_f32 v9, v117, v9
  v_cvt_pk_bf16_f32 v117, v9, v9
  v_and_b32 v92, v117, v12
  v_and_b32 v93, v117, v13
  v_and_b32 v94, v117, v14
  v_and_b32 v95, v117, v15
  s_waitcnt vmcnt(7)
  v_mfma_f32_16x16x32_bf16 v[36:39], v[80:83], v[64:67], 0
  s_waitcnt vmcnt(6)
  v_mfma_f32_16x16x32_bf16 v[36:39], v[84:87], v[68:71], v[36:39]
  s_waitcnt vmcnt(5)
  v_mfma_f32_16x16x32_bf16 v[36:39], v[88:91], v[72:75], v[36:39]
  s_waitcnt vmcnt(4)
  v_mfma_f32_16x16x32_bf16 v[36:39], v[92:95], v[76:79], v[36:39]
  s_nop 7
  v_permlane16_swap_b32 v36, v37
  v_permlane16_swap_b32 v38, v39
  s_nop 0
  v_add_f32_dpp v8, v37, v36 row_ror:8 row_mask:0xf bank_mask:0x3
  s_nop 1
  v_add_f32_dpp v8, v38, v39 row_ror:8 row_mask:0xf bank_mask:0xc

  ds_write_b32 v10, v8 offset:4096
  s_waitcnt lgkmcnt(0)
  s_barrier
  s_cmp_lg_u32 s38, 0
  s_cbranch_scc1 L_M_mrd
  ds_read2st64_b32 v[40:41], v11 offset0:16 offset1:17
  ds_read2st64_b32 v[42:43], v11 offset0:18 offset1:19
  ds_read2st64_b32 v[44:45], v11 offset0:20 offset1:21
  ds_read_b32 v46, v11 offset:5632

  s_mul_i32 s3, s68, 7168
  s_lshl_b32 s52, s69, 8
  s_add_u32 s3, s3, s52
  s_add_u32 s3, s3, 65536
  s_waitcnt lgkmcnt(0)
  v_add_f32 v40, v40, v41
  v_add_f32 v42, v42, v43
  v_add_f32 v44, v44, v45
  v_add_f32 v40, v40, v42
  v_add_f32 v44, v44, v46
  v_add_f32 v40, v40, v44

  v_bfi_b32 v40, s37, v22, v40
  buffer_store_dword v40, v11, s[32:35], s3 offen sc1
L_M_mrd:
  s_mov_b64 s[58:59], -1

  buffer_load_dwordx4 v[128:131], v27, s[32:35], s60 offen sc1
  buffer_load_dwordx4 v[132:135], v27, s[32:35], s82 offen sc1
  s_cmp_eq_u32 s38, 7
  s_cbranch_scc0 L_M_pt2
  v_lshlrev_b32 v112, 4, v0
  v_min_u32 v113, 47, v0
  v_lshlrev_b32 v113, 4, v113

  buffer_load_dwordx4 v[128:131], v112, s[32:35], s61 offen offset:0 sc1
  buffer_load_dwordx4 v[132:135], v113, s[32:35], s61 offen offset:1024 sc1
  s_mov_b32 s40, s26
  s_mov_b32 s41, s27
  s_mov_b32 s42, 896
  s_mov_b32 s43, 0x20000
  v_lshlrev_b32 v8, 1, v19
  s_mov_b32 exec_lo, 0x30003
  s_mov_b32 exec_hi, 0x30003
  buffer_store_short v25, v8, s[40:43], 0 offen
  s_mov_b64 exec, -1
L_M_pt2:
  v_mov_b32 v2, 2056
  v_mov_b32 v8, 0
  ds_write_b32 v2, v8
  s_mov_b32 s94, 0
  s_waitcnt lgkmcnt(0)
  s_barrier
  s_add_u32 m0, s80, 0
  s_nop 0
  buffer_load_dwordx4 v160, s[96:99], s63 offen lds
  s_add_u32 s63, s63, 57344
  s_add_u32 m0, s80, 1024
  s_nop 0
  buffer_load_dwordx4 v160, s[96:99], s63 offen lds
  s_add_u32 s63, s63, 57344
  s_add_u32 m0, s80, 2048
  s_nop 0
  buffer_load_dwordx4 v160, s[96:99], s63 offen lds
  s_add_u32 s63, s63, 57344
  s_add_u32 m0, s80, 3072
  s_nop 0
  buffer_load_dwordx4 v160, s[96:99], s63 offen lds
  s_add_u32 s63, s63, 57344
  s_add_u32 m0, s80, 4096
  s_nop 0
  buffer_load_dwordx4 v160, s[96:99], s63 offen lds
  s_add_u32 s63, s63, 57344
  s_mov_b32 s3, 0x10000
  buffer_load_dword v32, v23, s[32:35], s3 offen offset:0 sc1
  s_mov_b32 s3, 0x11000
  buffer_load_dword v33, v23, s[32:35], s3 offen offset:3072 sc1
  s_mov_b32 s3, 0x10000
  buffer_load_dword v34, v23, s[32:35], s3 offen offset:1792 sc1
  s_mov_b32 s3, 0x12000
  buffer_load_dword v35, v23, s[32:35], s3 offen offset:768 sc1
  s_mov_b32 s3, 0x10000
  buffer_load_dword v36, v23, s[32:35], s3 offen offset:3584 sc1
  s_mov_b32 s3, 0x12000
  buffer_load_dword v37, v23, s[32:35], s3 offen offset:2560 sc1
  s_mov_b32 s3, 0x11000
  buffer_load_dword v38, v20, s[32:35], s3 offen offset:1280 sc1
  s_mov_b32 s3, 0x13000
  buffer_load_dword v39, v20, s[32:35], s3 offen offset:256 sc1
  s_add_u32 m0, s80, 5120
  s_nop 0
  buffer_load_dwordx4 v160, s[96:99], s63 offen lds
  s_add_u32 s63, s63, 57344
  s_add_u32 m0, s80, 6144
  s_nop 0
  buffer_load_dwordx4 v160, s[96:99], s63 offen lds

  buffer_load_dwordx4 v[40:43], v27, s[32:35], s60 offen sc1
  buffer_load_dwordx4 v[44:47], v27, s[32:35], s82 offen sc1
  s_waitcnt vmcnt(11)
  v_xor_b32 v3, v32, v21
  v_and_b32 v32, 0xffffff00, v32
  s_waitcnt vmcnt(10)
  v_bitop3_b32 v3, v33, v21, v3 bitop3:0xbe
  v_and_b32 v33, 0xffffff00, v33
  s_waitcnt vmcnt(9)
  v_bitop3_b32 v3, v34, v21, v3 bitop3:0xbe
  v_and_b32 v34, 0xffffff00, v34
  s_waitcnt vmcnt(8)
  v_bitop3_b32 v3, v35, v21, v3 bitop3:0xbe
  v_and_b32 v35, 0xffffff00, v35
  s_waitcnt vmcnt(7)
  v_bitop3_b32 v3, v36, v21, v3 bitop3:0xbe
  v_and_b32 v36, 0xffffff00, v36
  s_waitcnt vmcnt(6)
  v_bitop3_b32 v3, v37, v21, v3 bitop3:0xbe
  v_and_b32 v37, 0xffffff00, v37
  s_waitcnt vmcnt(5)
  v_bitop3_b32 v3, v38, v21, v3 bitop3:0xbe
  v_and_b32 v38, 0xffffff00, v38
  s_waitcnt vmcnt(4)
  v_bitop3_b32 v3, v39, v21, v3 bitop3:0xbe
  v_and_b32 v39, 0xffffff00, v39
  v_and_b32 v3, s37, v3
  v_cmp_ne_u32 vcc, 0, v3
  s_cbranch_vccz L_M_r5ok
  s_mov_b32 s39, 0
L_mrest_1:
  s_mov_b32 s3, 0x10000
  buffer_load_dword v32, v23, s[32:35], s3 offen offset:0 sc1
  s_mov_b32 s3, 0x11000
  buffer_load_dword v33, v23, s[32:35], s3 offen offset:3072 sc1
  s_mov_b32 s3, 0x10000
  buffer_load_dword v34, v23, s[32:35], s3 offen offset:1792 sc1
  s_mov_b32 s3, 0x12000
  buffer_load_dword v35, v23, s[32:35], s3 offen offset:768 sc1
  s_mov_b32 s3, 0x10000
  buffer_load_dword v36, v23, s[32:35], s3 offen offset:3584 sc1
  s_mov_b32 s3, 0x12000
  buffer_load_dword v37, v23, s[32:35], s3 offen offset:2560 sc1
  s_mov_b32 s3, 0x11000
  buffer_load_dword v38, v20, s[32:35], s3 offen offset:1280 sc1
  s_mov_b32 s3, 0x13000
  buffer_load_dword v39, v20, s[32:35], s3 offen offset:256 sc1
  s_waitcnt vmcnt(7)
  v_xor_b32 v3, v32, v21
  v_and_b32 v32, 0xffffff00, v32
  s_waitcnt vmcnt(6)
  v_bitop3_b32 v3, v33, v21, v3 bitop3:0xbe
  v_and_b32 v33, 0xffffff00, v33
  s_waitcnt vmcnt(5)
  v_bitop3_b32 v3, v34, v21, v3 bitop3:0xbe
  v_and_b32 v34, 0xffffff00, v34
  s_waitcnt vmcnt(4)
  v_bitop3_b32 v3, v35, v21, v3 bitop3:0xbe
  v_and_b32 v35, 0xffffff00, v35
  s_waitcnt vmcnt(3)
  v_bitop3_b32 v3, v36, v21, v3 bitop3:0xbe
  v_and_b32 v36, 0xffffff00, v36
  s_waitcnt vmcnt(2)
  v_bitop3_b32 v3, v37, v21, v3 bitop3:0xbe
  v_and_b32 v37, 0xffffff00, v37
  s_waitcnt vmcnt(1)
  v_bitop3_b32 v3, v38, v21, v3 bitop3:0xbe
  v_and_b32 v38, 0xffffff00, v38
  s_waitcnt vmcnt(0)
  v_bitop3_b32 v3, v39, v21, v3 bitop3:0xbe
  v_and_b32 v39, 0xffffff00, v39
  v_and_b32 v3, s37, v3
  v_cmp_ne_u32 vcc, 0, v3
  s_cbranch_vccz L_mrestok_2

  s_add_u32 s39, s39, 1
  s_cmp_lt_u32 s39, 20000
  s_cbranch_scc1 L_mrest_1
L_mrestok_2:
L_M_r5ok:

  v_add_f32 v32, v32, v33
  v_add_f32 v34, v34, v35
  v_add_f32 v36, v36, v37
  v_add_f32 v38, v38, v39
  v_cvt_pk_bf16_f32 v16, 0, v32
  v_cvt_pk_bf16_f32 v34, 0, v34
  v_cvt_pk_bf16_f32 v36, 0, v36
  v_cvt_pk_bf16_f32 v9, 0, v38
  v_add_f32 v36, 1.0, v36
  v_cvt_pk_bf16_f32 v18, 0, v36

  v_lshlrev_b32 v25, 16, v25
  ds_write_b16_d16_hi v5, v18 offset:2112
  ds_write_b16_d16_hi v5, v34 offset:3168
  v_mov_b32 v144, 0
  v_mov_b32 v145, 0
  v_mov_b32 v146, 0
  v_mov_b32 v147, 0
  v_mov_b32 v148, 0
  v_mov_b32 v149, 0
  v_mov_b32 v150, 0
  v_mov_b32 v151, 0
  v_mov_b32 v152, 0
  v_mov_b32 v153, 0
  v_mov_b32 v154, 0
  v_mov_b32 v155, 0
  v_mov_b32 v156, 0
  v_mov_b32 v157, 0
  v_mov_b32 v158, 0
  v_mov_b32 v159, 0
  s_waitcnt vmcnt(2)
  v_mov_b32 v8, 1
  s_mov_b64 exec, 1
  ds_add_u32 v2, v8
  s_mov_b64 exec, -1

  s_cmp_eq_u32 s38, 7
  s_cbranch_scc1 L_M_fin
  s_mov_b32 s39, 0
  s_cmp_ge_u32 s38, 4
  s_cbranch_scc1 L_M_wd6
  s_add_u32 m0, s81, 0
  s_nop 0
  buffer_load_dwordx4 v161, s[64:67], s62 offen nt lds
  s_add_u32 s62, s62, 7168
  s_add_u32 m0, s81, 1024
  s_nop 0
  buffer_load_dwordx4 v162, s[64:67], s62 offen nt lds
  s_add_u32 s62, s62, 7168
  s_add_u32 m0, s81, 2048
  s_nop 0
  buffer_load_dwordx4 v161, s[64:67], s62 offen nt lds
  s_add_u32 s62, s62, 7168
  s_add_u32 m0, s81, 3072
  s_nop 0
  buffer_load_dwordx4 v162, s[64:67], s62 offen nt lds
L_wdsk_3:
L_M_wd6:

  v_mov_b32 v21, 0xbdd2d3e8
  v_mov_b32 v23, 1.0
L_M_r4chk:
  s_waitcnt vmcnt(1)
  v_xor_b32 v3, v40, v22
  v_and_b32 v40, 0xffffff00, v40
  s_waitcnt vmcnt(0)
  v_bitop3_b32 v3, v44, v22, v3 bitop3:0xbe
  v_and_b32 v44, 0xffffff00, v44
  v_and_b32 v3, s37, v3
  v_cmp_ne_u32 vcc, 0, v3

  v_pk_add_f32 v[32:33], v[40:41], v[44:45]
  v_pk_add_f32 v[34:35], v[42:43], v[46:47]

  s_nop 0
  v_permlane16_swap_b32 v32, v33
  v_permlane16_swap_b32 v34, v35
  v_add_f32 v32, v32, v33
  v_add_f32 v34, v34, v35
  s_nop 1
  v_permlane32_swap_b32 v32, v34
  v_add_f32 v32, v32, v34
  v_cvt_pk_bf16_f32 v32, 0, v32
  v_mul_f32 v32, v16, v32
  v_cvt_pk_bf16_f32 v32, 0, v32
  v_add_f32 v32, v25, v32
  v_cvt_pk_bf16_f32 v32, 0, v32
  v_mul_f32 v33, v32, v18
  s_cbranch_vccnz L_M_r4re
L_M_r4ok:

  ds_write_b32 v4, v32
  v_cvt_pk_bf16_f32 v34, 0, v33
  v_sub_f32 v33, v33, v34
  ds_write_b16_d16_hi v5, v34
  v_cvt_pk_bf16_f32 v33, v33, v33
  ds_write_b16 v5, v33 offset:1056
  s_cmp_ge_u32 s38, 4
  s_cbranch_scc1 L_M_b1w
  ds_read_b64_tr_b16 v[128:129], v164 offset:0
  ds_read_b64_tr_b16 v[130:131], v164 offset:512
  ds_read_b64_tr_b16 v[132:133], v165 offset:0
  ds_read_b64_tr_b16 v[134:135], v165 offset:512
  ds_read_b64_tr_b16 v[136:137], v166 offset:0
  ds_read_b64_tr_b16 v[138:139], v166 offset:512
  ds_read_b64_tr_b16 v[140:141], v167 offset:0
  ds_read_b64_tr_b16 v[142:143], v167 offset:512

  s_cmp_lg_u32 s94, 0
  s_cbranch_scc0 L_M_trl
  s_waitcnt lgkmcnt(8)
  s_branch L_M_b1
L_M_b1w:
  s_waitcnt lgkmcnt(0)
L_M_b1:
  s_barrier
  s_cmp_ge_u32 s38, 4
  s_cbranch_scc1 L_M_b2
  ds_read_b128 v[32:35], v6 offset:0
  ds_read2st64_b32 v[64:65], v7 offset0:0 offset1:1
  ds_read2st64_b32 v[66:67], v7 offset0:2 offset1:3
  ds_read2st64_b32 v[68:69], v7 offset0:4 offset1:5
  ds_read_b32 v70, v7 offset:1536
  ds_read_b128 v[36:39], v6 offset:256
  ds_read_b128 v[40:43], v6 offset:512
  ds_read_b128 v[44:47], v6 offset:768
  s_mov_b32 s3, 0x3b124925
  s_waitcnt lgkmcnt(7)
  v_mfma_f32_16x16x32_bf16 v[48:51], v[32:35], v[72:75], 0
  v_mfma_f32_16x16x32_bf16 v[52:55], v[32:35], v[76:79], 0
  s_waitcnt lgkmcnt(3)
  v_pk_mul_f32 v[2:3], v[64:65], v[64:65]
  v_pk_add_f32 v[64:65], v[64:65], v[66:67]
  v_pk_fma_f32 v[2:3], v[66:67], v[66:67], v[2:3]
  v_mfma_f32_16x16x32_bf16 v[56:59], v[32:35], v[80:83], 0
  v_pk_add_f32 v[64:65], v[64:65], v[68:69]
  v_pk_fma_f32 v[2:3], v[68:69], v[68:69], v[2:3]
  v_add_f32 v64, v64, v70
  v_mfma_f32_16x16x32_bf16 v[60:63], v[32:35], v[84:87], 0
  v_fmac_f32 v2, v70, v70
  v_add_f32 v64, v64, v65
  v_add_f32 v65, v2, v3
  s_waitcnt lgkmcnt(2)
  v_mfma_f32_16x16x32_bf16 v[48:51], v[36:39], v[88:91], v[48:51]
  v_add_f32_dpp v64, v64, v64 row_ror:8 row_mask:0xf bank_mask:0xf
  v_add_f32_dpp v65, v65, v65 row_ror:8 row_mask:0xf bank_mask:0xf
  s_nop 0
  v_add_f32_dpp v64, v64, v64 row_ror:4 row_mask:0xf bank_mask:0xf
  v_mfma_f32_16x16x32_bf16 v[52:55], v[36:39], v[92:95], v[52:55]
  v_add_f32_dpp v65, v65, v65 row_ror:4 row_mask:0xf bank_mask:0xf
  v_add_f32_dpp v64, v64, v64 row_ror:2 row_mask:0xf bank_mask:0xf
  s_nop 0
  v_add_f32_dpp v65, v65, v65 row_ror:2 row_mask:0xf bank_mask:0xf
  v_mfma_f32_16x16x32_bf16 v[56:59], v[36:39], v[96:99], v[56:59]
  v_add_f32_dpp v64, v64, v64 row_ror:1 row_mask:0xf bank_mask:0xf
  v_add_f32_dpp v65, v65, v65 row_ror:1 row_mask:0xf bank_mask:0xf
  s_nop 1
  v_permlane16_swap_b32 v64, v65
  v_mfma_f32_16x16x32_bf16 v[60:63], v[36:39], v[100:103], v[60:63]
  v_add_f32 v64, v64, v65
  v_mov_b32 v65, v64
  s_nop 1
  v_permlane32_swap_b32 v64, v65
  s_waitcnt lgkmcnt(1)
  v_mfma_f32_16x16x32_bf16 v[48:51], v[40:43], v[104:107], v[48:51]
  v_add_f32 v64, v64, v65
  v_mov_b32 v65, v64
  s_nop 1
  v_permlane16_swap_b32 v64, v65
  v_mfma_f32_16x16x32_bf16 v[52:55], v[40:43], v[108:111], v[52:55]
  v_mul_f32 v64, s3, v64
  v_mul_f32 v65, s3, v65
  v_fma_f32 v65, -v64, v64, v65
  v_mfma_f32_16x16x32_bf16 v[56:59], v[40:43], v[112:115], v[56:59]
  v_max_f32 v65, 0, v65
  v_cvt_pk_bf16_f32 v64, 0, v64
  v_cvt_pk_bf16_f32 v65, 0, v65
  v_mfma_f32_16x16x32_bf16 v[60:63], v[40:43], v[116:119], v[60:63]
  v_add_f32 v65, 0x3727c5ac, v65
  v_cvt_pk_bf16_f32 v65, 0, v65
  v_sqrt_f32 v65, v65
  s_waitcnt lgkmcnt(0)
  v_mfma_f32_16x16x32_bf16 v[48:51], v[44:47], v[120:123], v[48:51]
  v_cvt_pk_bf16_f32 v65, 0, v65
  v_rcp_f32 v65, v65
  s_nop 1
  v_mul_f32_dpp v65, v65, -v64 quad_perm:[0,1,2,3] row_mask:0x4 bank_mask:0xf
  v_mfma_f32_16x16x32_bf16 v[52:55], v[44:47], v[124:127], v[52:55]
  s_nop 0
  v_mov_b32_dpp v65, v23 quad_perm:[0,1,2,3] row_mask:0x8 bank_mask:0xf

  s_nop 5
  v_add_f32 v48, v48, v53
  v_add_f32 v58, v58, v63
  v_add_f32 v48, v48, v58

  v_mul_f32 v48, v48, v65
  v_mov_b32 v49, v48
  s_nop 1
  v_permlane16_swap_b32 v48, v49
  v_add_f32 v48, v48, v49
  v_mov_b32 v49, v48
  s_nop 1
  v_permlane32_swap_b32 v48, v49
  v_add_f32 v48, v48, v49
  v_cvt_pk_bf16_f32 v48, 0, v48

  v_mul_f32 v50, v48, v48
  s_nop 0
  v_mov_b32_dpp v49, v48 row_ror:8 row_mask:0xf bank_mask:0xf
  v_fmaak_f32 v50, v50, v21, 0xc0135761
  v_mul_f32 v50, v50, v48
  v_exp_f32 v50, v50
  s_nop 0
  v_add_f32 v50, 1.0, v50
  v_rcp_f32 v50, v50
  s_nop 0
  v_mul_f32 v50, v50, v48
  v_cvt_pk_bf16_f32 v50, 0, v50
  v_mul_f32 v50, v50, v49
  v_cvt_pk_bf16_f32 v50, v50, v50
  s_mov_b64 exec, 0xff
  ds_write_b16 v24, v50
  s_mov_b64 exec, -1
  s_waitcnt lgkmcnt(0)
  s_barrier
L_M_dn:
  s_mov_b64 exec, s[84:85]
  ds_read_b128 v[144:147], v26
  s_mov_b64 exec, s[86:87]
  ds_read_b128 v[148:151], v26
  s_mov_b64 exec, s[88:89]
  ds_read_b128 v[152:155], v26
  s_mov_b64 exec, s[90:91]
  ds_read_b128 v[156:159], v26
  s_mov_b64 exec, s[92:93]
  s_waitcnt lgkmcnt(3)
  v_mfma_f32_16x16x32_bf16 v[36:39], v[128:131], v[144:147], 0
  s_waitcnt lgkmcnt(2)
  v_mfma_f32_16x16x32_bf16 v[36:39], v[132:135], v[148:151], v[36:39]
  s_waitcnt lgkmcnt(1)
  v_mfma_f32_16x16x32_bf16 v[36:39], v[136:139], v[152:155], v[36:39]
  s_waitcnt lgkmcnt(0)
  v_mfma_f32_16x16x32_bf16 v[36:39], v[140:143], v[156:159], v[36:39]

  s_nop 7
  v_bfi_b32 v36, s37, v17, v36
  v_bfi_b32 v37, s37, v28, v37
  buffer_store_dwordx4 v[36:39], v1, s[32:35], s83 offen sc1
  s_mov_b64 exec, -1

  s_waitcnt vmcnt(0)
  s_barrier
  s_branch L_M_done
L_M_b2:
  s_add_u32 m0, s81, 0
  s_nop 0
  buffer_load_dwordx4 v161, s[64:67], s62 offen nt lds
  s_add_u32 s62, s62, 7168
  s_add_u32 m0, s81, 1024
  s_nop 0
  buffer_load_dwordx4 v162, s[64:67], s62 offen nt lds
  s_add_u32 s62, s62, 7168
  s_add_u32 m0, s81, 2048
  s_nop 0
  buffer_load_dwordx4 v161, s[64:67], s62 offen nt lds
  s_add_u32 s62, s62, 7168
  s_add_u32 m0, s81, 3072
  s_nop 0
  buffer_load_dwordx4 v162, s[64:67], s62 offen nt lds
L_wdsk_4:
  s_waitcnt vmcnt(0)
  ds_read_b64_tr_b16 v[128:129], v164 offset:0
  ds_read_b64_tr_b16 v[130:131], v164 offset:512
  ds_read_b64_tr_b16 v[132:133], v165 offset:0
  ds_read_b64_tr_b16 v[134:135], v165 offset:512
  ds_read_b64_tr_b16 v[136:137], v166 offset:0
  ds_read_b64_tr_b16 v[138:139], v166 offset:512
  ds_read_b64_tr_b16 v[140:141], v167 offset:0
  ds_read_b64_tr_b16 v[142:143], v167 offset:512

  s_waitcnt lgkmcnt(0)
  s_barrier
  s_branch L_M_dn
L_M_r4re:
  s_add_u32 s39, s39, 1
  s_cmp_ge_u32 s39, 20000
  s_cbranch_scc1 L_M_r4ok

  buffer_load_dwordx4 v[40:43], v27, s[32:35], s60 offen sc1
  buffer_load_dwordx4 v[44:47], v27, s[32:35], s82 offen sc1

  s_cmp_ge_u32 s38, 4
  s_cselect_b32 s94, 1, s94
  s_cmp_lg_u32 s94, 0
  s_cbranch_scc1 L_M_r4chk
  ds_read_b32 v8, v2
  s_waitcnt lgkmcnt(0)
  v_cmp_ne_u32 vcc, 8, v8
  s_cbranch_vccnz L_M_r4chk
  s_mov_b32 s94, 1
  ds_read_b64_tr_b16 v[72:73], v163 offset:0
  ds_read_b64_tr_b16 v[74:75], v163 offset:256
  ds_read_b64_tr_b16 v[76:77], v163 offset:2048
  ds_read_b64_tr_b16 v[78:79], v163 offset:2304
  ds_read_b64_tr_b16 v[80:81], v163 offset:4096
  ds_read_b64_tr_b16 v[82:83], v163 offset:4352
  ds_read_b64_tr_b16 v[84:85], v163 offset:6144
  ds_read_b64_tr_b16 v[86:87], v163 offset:6400
  ds_read_b64_tr_b16 v[88:89], v163 offset:8192
  ds_read_b64_tr_b16 v[90:91], v163 offset:8448
  ds_read_b64_tr_b16 v[92:93], v163 offset:10240
  ds_read_b64_tr_b16 v[94:95], v163 offset:10496
  ds_read_b64_tr_b16 v[96:97], v163 offset:12288
  ds_read_b64_tr_b16 v[98:99], v163 offset:12544
  ds_read_b64_tr_b16 v[100:101], v163 offset:14336
  ds_read_b64_tr_b16 v[102:103], v163 offset:14592
  ds_read_b64_tr_b16 v[104:105], v163 offset:16384
  ds_read_b64_tr_b16 v[106:107], v163 offset:16640
  ds_read_b64_tr_b16 v[108:109], v163 offset:18432
  ds_read_b64_tr_b16 v[110:111], v163 offset:18688
  ds_read_b64_tr_b16 v[112:113], v163 offset:20480
  ds_read_b64_tr_b16 v[114:115], v163 offset:20736
  ds_read_b64_tr_b16 v[116:117], v163 offset:22528
  ds_read_b64_tr_b16 v[118:119], v163 offset:22784
  ds_read_b64_tr_b16 v[120:121], v163 offset:24576
  ds_read_b64_tr_b16 v[122:123], v163 offset:24832
  ds_read_b64_tr_b16 v[124:125], v163 offset:26624
  ds_read_b64_tr_b16 v[126:127], v163 offset:26880

  s_branch L_M_r4chk
L_M_trl:
  ds_read_b32 v8, v2
  s_waitcnt lgkmcnt(0)
  v_cmp_ne_u32 vcc, 8, v8
  s_cbranch_vccnz L_M_trl
  ds_read_b64_tr_b16 v[72:73], v163 offset:0
  ds_read_b64_tr_b16 v[74:75], v163 offset:256
  ds_read_b64_tr_b16 v[76:77], v163 offset:2048
  ds_read_b64_tr_b16 v[78:79], v163 offset:2304
  ds_read_b64_tr_b16 v[80:81], v163 offset:4096
  ds_read_b64_tr_b16 v[82:83], v163 offset:4352
  ds_read_b64_tr_b16 v[84:85], v163 offset:6144
  ds_read_b64_tr_b16 v[86:87], v163 offset:6400
  ds_read_b64_tr_b16 v[88:89], v163 offset:8192
  ds_read_b64_tr_b16 v[90:91], v163 offset:8448
  ds_read_b64_tr_b16 v[92:93], v163 offset:10240
  ds_read_b64_tr_b16 v[94:95], v163 offset:10496
  ds_read_b64_tr_b16 v[96:97], v163 offset:12288
  ds_read_b64_tr_b16 v[98:99], v163 offset:12544
  ds_read_b64_tr_b16 v[100:101], v163 offset:14336
  ds_read_b64_tr_b16 v[102:103], v163 offset:14592
  ds_read_b64_tr_b16 v[104:105], v163 offset:16384
  ds_read_b64_tr_b16 v[106:107], v163 offset:16640
  ds_read_b64_tr_b16 v[108:109], v163 offset:18432
  ds_read_b64_tr_b16 v[110:111], v163 offset:18688
  ds_read_b64_tr_b16 v[112:113], v163 offset:20480
  ds_read_b64_tr_b16 v[114:115], v163 offset:20736
  ds_read_b64_tr_b16 v[116:117], v163 offset:22528
  ds_read_b64_tr_b16 v[118:119], v163 offset:22784
  ds_read_b64_tr_b16 v[120:121], v163 offset:24576
  ds_read_b64_tr_b16 v[122:123], v163 offset:24832
  ds_read_b64_tr_b16 v[124:125], v163 offset:26624
  ds_read_b64_tr_b16 v[126:127], v163 offset:26880
  s_branch L_M_b1

  s_branch L_M_r4chk
L_M_fin:

  v_lshlrev_b32 v112, 4, v0
  v_min_u32 v113, 47, v0
  v_lshlrev_b32 v113, 4, v113
  v_min_u32 v123, 47, v0
  v_and_b32 v123, 3, v123
  v_and_b32 v122, 3, v0
  v_lshlrev_b32 v123, 3, v123
  v_lshlrev_b32 v122, 3, v122
  v_lshrrev_b32 v114, v123, s36
  v_xor_b32 v122, 16, v122
  v_xor_b32 v123, 16, v123
  v_lshrrev_b32 v122, v122, s36
  v_lshrrev_b32 v123, v123, s36
  v_lshlrev_b32 v19, 1, v19

  s_waitcnt vmcnt(0) lgkmcnt(0)

  s_barrier
  ds_read_b32 v16, v20 offset:2176
  s_mov_b32 s40, s26
  s_mov_b32 s41, s27
  s_mov_b32 s42, 896
  s_mov_b32 s43, 0x20000
  s_barrier
  s_barrier
  s_mov_b32 s39, 0
L_fin_5:

  buffer_load_dwordx4 v[32:35], v112, s[32:35], s61 offen offset:0 sc1
  buffer_load_dwordx4 v[36:39], v113, s[32:35], s61 offen offset:1024 sc1
  s_waitcnt vmcnt(1)
  v_xor_b32 v3, v32, v22
  v_and_b32 v32, 0xffffff00, v32
  v_bitop3_b32 v3, v33, v122, v3 bitop3:0xbe
  v_and_b32 v33, 0xffffff00, v33
  s_waitcnt vmcnt(0)
  v_bitop3_b32 v3, v36, v114, v3 bitop3:0xbe
  v_and_b32 v36, 0xffffff00, v36
  v_bitop3_b32 v3, v37, v123, v3 bitop3:0xbe
  v_and_b32 v37, 0xffffff00, v37
  v_and_b32 v3, s37, v3
  v_cmp_ne_u32 vcc, 0, v3

  s_mov_b32 exec_hi, 0xffff
  v_pk_add_f32 v[32:33], v[32:33], v[36:37]
  v_pk_add_f32 v[34:35], v[34:35], v[38:39]
  s_mov_b32 exec_hi, -1
  v_permlane16_swap_b32 v32, v33
  v_permlane16_swap_b32 v34, v35
  v_add_f32 v32, v32, v33
  v_add_f32 v34, v34, v35
  s_nop 1
  v_permlane32_swap_b32 v32, v34
  v_add_f32 v32, v32, v34
  s_nop 1
  v_add_f32_dpp v32, v32, v32 row_ror:2 row_mask:0xf bank_mask:0xf
  s_nop 1
  v_add_f32_dpp v32, v32, v32 row_ror:4 row_mask:0xf bank_mask:0xf
  s_nop 1
  v_add_f32_dpp v32, v32, v32 row_ror:8 row_mask:0xf bank_mask:0xf
  v_cvt_pk_bf16_f32 v32, 0, v32
  v_mul_f32 v32, v9, v32
  v_cvt_pk_bf16_f32 v32, 0, v32
  s_cbranch_vccz L_finok_6
  s_add_u32 s39, s39, 1
  s_cmp_lt_u32 s39, 20000
  s_cbranch_scc1 L_fin_5
L_finok_6:
  s_waitcnt lgkmcnt(0)

  v_add_f32 v32, v16, v32
  v_cvt_pk_bf16_f32 v32, v32, v32
  s_mov_b32 exec_lo, 0x30003
  s_mov_b32 exec_hi, 0x30003
  buffer_store_short v32, v19, s[40:43], 0 offen
  s_cmp_lg_u32 s44, 0
  s_cbranch_scc1 L_M_noep
  s_mov_b64 exec, 1
  v_mov_b32 v32, s36
  v_mov_b32 v33, 0
  buffer_store_dword v32, v33, s[32:35], 0 offen sc1
L_M_noep:
  s_mov_b64 exec, -1
L_M_done:
  s_endpgm
L_Q:

  s_sub_u32 s44, s2, 184
  v_lshrrev_b32 v29, 4, v0
  v_bfe_u32 v28, v0, 2, 1
  v_bfe_u32 v27, v0, 3, 1
  v_and_b32 v26, 7, v0
  v_mul_u32_u24 v1, 14, v29
  v_mul_u32_u24 v2, 7, v27
  v_add_u32 v1, v1, v2
  v_lshlrev_b32 v1, 13, v1
  v_lshl_add_u32 v1, v26, 4, v1
  s_and_b32 s55, s44, 7
  s_lshr_b32 s56, s44, 3
  s_lshl_b32 s53, s55, 3
  s_add_u32 s53, s53, s56
  s_mul_i32 s52, s38, 458752
  s_lshl_b32 s3, s53, 7
  s_add_u32 s52, s52, s3
  v_bfe_u32 v3, v0, 3, 1
  v_and_b32 v24, 3, v0
  v_lshl_add_u32 v24, v3, 2, v24
  v_min_u32 v24, 6, v24
  v_bfe_u32 v3, v0, 2, 1
  v_mul_u32_u24 v3, 7, v3
  v_add_u32 v24, v24, v3
  v_lshrrev_b32 v3, 4, v0
  v_mul_u32_u24 v3, 14, v3
  v_add_u32 v24, v24, v3
  s_mul_i32 s3, s38, 56
  v_add_u32 v24, s3, v24
  v_lshlrev_b32 v3, 1, v24
  s_waitcnt lgkmcnt(0)
  s_load_dword s36, s[30:31], 0
  s_mov_b32 s32, s30
  s_mov_b32 s33, s31
  s_mov_b32 s34, 268435456
  s_mov_b32 s35, 0x20000
  s_mov_b32 s40, s4
  s_mov_b32 s41, s5
  s_mov_b32 s42, 896
  s_mov_b32 s43, 0x20000
  s_mov_b32 s48, s10
  s_mov_b32 s49, s11
  s_mov_b32 s50, 3670016
  s_mov_b32 s51, 0x20000
  buffer_load_ushort v25, v3, s[40:43], 0 offen

  s_lshl_b32 s57, s55, 14
  s_lshl_b32 s3, s56, 13
  s_add_u32 s57, s57, s3
  s_add_u32 s57, s57, 3145728
  s_lshr_b32 s3, s56, 1
  s_or_b32 s3, s3, s38
  s_cselect_b32 s57, 0x40000000, s57
  v_lshlrev_b32 v2, 7, v0
  buffer_load_dword v126, v2, s[32:35], s57 offen sc1
  buffer_load_dwordx4 v[64:67], v1, s[48:51], s52 offen nt
  s_add_u32 s52, s52, 8192
  buffer_load_dwordx4 v[68:71], v1, s[48:51], s52 offen nt
  s_add_u32 s52, s52, 8192
  buffer_load_dwordx4 v[72:75], v1, s[48:51], s52 offen nt
  s_add_u32 s52, s52, 8192
  buffer_load_dwordx4 v[76:79], v1, s[48:51], s52 offen nt
  s_add_u32 s52, s52, 8192
  buffer_load_dwordx4 v[80:83], v1, s[48:51], s52 offen nt
  s_add_u32 s52, s52, 8192

  s_lshl_b32 s54, s53, 13
  s_lshl_b32 s3, s38, 10
  s_add_u32 s54, s54, s3
  s_add_u32 s54, s54, 2097152

  v_lshlrev_b32 v23, 2, v24
  s_lshl_b32 s3, s55, 14
  v_add_u32 v20, s3, v23

  v_and_b32 v3, 1, v0
  v_mov_b32 v7, 0xffff
  v_lshlrev_b32 v3, 4, v3
  v_lshlrev_b32 v7, v3, v7
  v_bfe_u32 v3, v0, 3, 1
  v_lshlrev_b32 v3, 1, v3
  v_bfe_u32 v15, v0, 1, 1
  v_add_u32 v3, v3, v15
  v_cmp_eq_u32 vcc, 0, v3
  s_nop 1
  v_cndmask_b32 v12, 0, v7, vcc
  v_cmp_eq_u32 vcc, 1, v3
  s_nop 1
  v_cndmask_b32 v13, 0, v7, vcc
  v_cmp_eq_u32 vcc, 2, v3
  s_nop 1
  v_cndmask_b32 v14, 0, v7, vcc
  v_cmp_eq_u32 vcc, 3, v3
  s_nop 1
  v_cndmask_b32 v15, 0, v7, vcc
  v_and_b32 v10, 7, v0
  v_lshlrev_b32 v10, 5, v10
  v_lshrrev_b32 v3, 5, v0
  v_lshl_add_u32 v10, v3, 4, v10
  v_bfe_u32 v3, v0, 4, 1
  v_lshl_add_u32 v10, v3, 2, v10
  v_bfe_u32 v3, v0, 3, 1
  v_lshl_add_u32 v10, v3, 3, v10

  s_lshl_b32 s3, s38, 8
  v_add_u32 v10, s3, v10
  v_lshlrev_b32 v11, 2, v0
  v_lshrrev_b32 v6, 2, v0
  v_and_b32 v7, 3, v0
  v_lshlrev_b32 v9, 4, v6
  v_lshl_add_u32 v9, v7, 8, v9
  v_mul_u32_u24 v6, 24, v6
  v_lshl_add_u32 v6, v7, 3, v6
  v_and_b32 v3, 11, v0
  v_cmp_ne_u32 vcc, 11, v3
  v_lshlrev_b32 v2, 5, v29
  s_lshl_b32 s3, s38, 2
  s_add_u32 s3, s3, 2048
  v_add_u32 v2, s3, v2
  v_mov_b32 v7, 2048
  s_waitcnt vmcnt(6)

  buffer_load_dwordx4 v[84:87], v1, s[48:51], s52 offen nt
  s_add_u32 s52, s52, 8192
  buffer_load_dwordx4 v[88:91], v1, s[48:51], s52 offen nt

  v_lshlrev_b32 v25, 16, v25
  v_cndmask_b32 v33, 0, v25, vcc
  v_mul_f32 v34, v33, v33

  s_nop 0
  v_add_f32_dpp v33, v33, v33 row_ror:8 row_mask:0xf bank_mask:0xf
  v_add_f32_dpp v34, v34, v34 row_ror:8 row_mask:0xf bank_mask:0xf
  s_nop 0
  v_add_f32_dpp v33, v33, v33 row_ror:4 row_mask:0xf bank_mask:0xf
  v_add_f32_dpp v34, v34, v34 row_ror:4 row_mask:0xf bank_mask:0xf
  s_nop 0
  v_add_f32_dpp v33, v33, v33 row_ror:2 row_mask:0xf bank_mask:0xf
  v_add_f32_dpp v34, v34, v34 row_ror:2 row_mask:0xf bank_mask:0xf
  s_nop 0
  v_add_f32_dpp v33, v33, v33 row_ror:1 row_mask:0xf bank_mask:0xf
  v_add_f32_dpp v34, v34, v34 row_ror:1 row_mask:0xf bank_mask:0xf

  s_nop 1
  v_permlane16_swap_b32 v33, v34
  v_add_f32 v33, v33, v34
  v_mov_b32 v34, v33
  s_nop 1
  v_permlane32_swap_b32 v33, v34
  v_add_f32 v33, v33, v34
  s_mov_b64 exec, 0x10001
  ds_write_b32 v2, v33
  s_mov_b64 exec, -1
  s_waitcnt lgkmcnt(0)
  s_barrier

  ds_read_b128 v[40:43], v7
  ds_read_b128 v[44:47], v7 offset:16
  ds_read_b128 v[48:51], v7 offset:32
  ds_read_b128 v[52:55], v7 offset:48
  s_mov_b32 s3, 0x3b124925
  s_waitcnt lgkmcnt(2)
  v_pk_add_f32 v[40:41], v[40:41], v[42:43]
  v_pk_add_f32 v[44:45], v[44:45], v[46:47]
  s_waitcnt lgkmcnt(0)
  v_pk_add_f32 v[48:49], v[48:49], v[50:51]
  v_pk_add_f32 v[52:53], v[52:53], v[54:55]
  v_pk_add_f32 v[40:41], v[40:41], v[44:45]
  v_pk_add_f32 v[48:49], v[48:49], v[52:53]
  v_add_f32 v40, v40, v41
  v_add_f32 v48, v48, v49
  v_mul_f32 v32, s3, v40
  v_mul_f32 v48, s3, v48
  v_fma_f32 v33, -v32, v32, v48
  v_max_f32 v33, 0, v33

  v_cvt_pk_bf16_f32 v32, 0, v32
  v_cvt_pk_bf16_f32 v33, 0, v33
  v_add_f32 v33, 0x3727c5ac, v33
  v_cvt_pk_bf16_f32 v33, 0, v33
  v_sqrt_f32 v33, v33
  v_sub_f32 v25, v25, v32
  v_cvt_pk_bf16_f32 v33, 0, v33
  v_cvt_pk_bf16_f32 v25, 0, v25
  v_rcp_f32 v33, v33
  s_nop 0
  v_mul_f32 v25, v25, v33
  v_cvt_pk_bf16_f32 v25, 0, v25
  s_waitcnt lgkmcnt(0)
  s_mul_i32 s36, s36, 0x9E3779B1
  s_add_u32 s36, s36, 0x7F4A7C15

  v_and_b32 v3, 3, v0
  v_lshlrev_b32 v3, 3, v3
  v_lshrrev_b32 v22, v3, s36
  v_and_b32 v3, 3, v24
  v_lshlrev_b32 v3, 3, v3
  v_lshrrev_b32 v21, v3, s36
  s_lshl_b32 s53, s53, 10
  s_add_u32 s53, s53, 196608
  s_cmp_eq_u32 s38, 0
  s_cselect_b32 s53, s53, 0x40000000
  v_mov_b32 v59, s36

  s_waitcnt vmcnt(0)
  s_barrier
  s_mov_b32 s39, 0
L_sc_7:
  s_mov_b32 s3, 0x300000
  buffer_load_dword v32, v20, s[32:35], s3 offen offset:0 sc1
  buffer_load_dword v33, v20, s[32:35], s3 offen offset:3584 sc1
  s_mov_b32 s3, 0x301000
  buffer_load_dword v34, v20, s[32:35], s3 offen offset:3072 sc1
  s_mov_b32 s3, 0x302000
  buffer_load_dword v35, v20, s[32:35], s3 offen offset:2560 sc1
  s_mov_b32 s3, 0x300000
  buffer_load_dword v36, v20, s[32:35], s3 offen offset:1792 sc1
  s_mov_b32 s3, 0x301000
  buffer_load_dword v37, v20, s[32:35], s3 offen offset:1280 sc1
  s_mov_b32 s3, 0x302000
  buffer_load_dword v38, v20, s[32:35], s3 offen offset:768 sc1
  s_mov_b32 s3, 0x303000
  buffer_load_dword v39, v20, s[32:35], s3 offen offset:256 sc1

  s_lshr_b32 s64, s38, 2
  s_lshl_b32 s65, s55, 1
  s_add_u32 s64, s64, s65
  s_and_b32 s65, s38, 3
  s_lshl_b32 s66, s64, 8
  s_add_u32 s67, s66, 851968
  s_lshl_b32 s68, s65, 6
  s_add_u32 s66, s66, s68
  s_mul_i32 s66, s66, 896
  s_lshl_b32 s68, s56, 7
  s_add_u32 s66, s66, s68
  s_cmp_eq_u32 s56, 7
  s_cselect_b32 s66, 0x40000000, s66

  s_lshl_b32 s64, s64, 14
  s_lshl_b32 s65, s65, 12
  s_add_u32 s64, s64, s65
  s_add_u32 s64, s64, 2621440
  s_lshl_b32 s65, s38, 15
  s_mul_i32 s68, s55, 1792
  s_add_u32 s65, s65, s68
  s_lshl_b32 s68, s56, 8
  s_add_u32 s65, s65, s68
  s_add_u32 s65, s65, 3276800
  s_lshl_b32 s68, s38, 13
  s_add_u32 s68, s68, 8192
  s_mov_b32 s70, 0x11111111
  s_mov_b32 s71, s70
  v_bfe_u32 v111, v0, 4, 1
  v_lshlrev_b32 v100, 1, v111
  v_xor_b32 v100, v100, v26
  v_lshlrev_b32 v100, 4, v100
  v_lshl_add_u32 v101, v27, 4, v29
  v_mul_u32_u24 v101, 896, v101
  v_add_u32 v100, v101, v100
  v_xor_b32 v101, 64, v100
  v_bfe_u32 v110, v0, 2, 2
  v_lshlrev_b32 v102, 7, v110
  v_lshl_add_u32 v102, v29, 10, v102
  v_lshl_add_u32 v102, v27, 5, v102
  v_lshl_add_u32 v102, v111, 6, v102
  v_and_b32 v111, 3, v0
  v_lshl_add_u32 v102, v111, 3, v102
  v_add_u32 v102, s68, v102
  v_xor_b32 v103, 32, v102
  v_xor_b32 v104, 64, v102
  v_xor_b32 v105, 96, v102
  v_and_b32 v106, 15, v0
  v_lshlrev_b32 v106, 6, v106
  v_lshl_add_u32 v106, v29, 4, v106
  v_lshl_add_u32 v107, v29, 2, v111
  v_lshlrev_b32 v107, 4, v107
  s_lshl_b32 s69, s38, 8
  v_add_u32 v108, s69, v11
  v_lshlrev_b32 v110, 3, v110
  v_lshrrev_b32 v110, v110, s36
  s_mov_b32 s60, s12
  s_mov_b32 s61, s13
  s_mov_b32 s62, 3670016
  s_mov_b32 s63, 0x20000
  s_waitcnt vmcnt(7)
  v_xor_b32 v3, v32, v21
  v_and_b32 v32, 0xffffff00, v32
  s_waitcnt vmcnt(6)
  v_bitop3_b32 v3, v33, v21, v3 bitop3:0xbe
  v_and_b32 v33, 0xffffff00, v33
  s_waitcnt vmcnt(5)
  v_bitop3_b32 v3, v34, v21, v3 bitop3:0xbe
  v_and_b32 v34, 0xffffff00, v34
  s_waitcnt vmcnt(4)
  v_bitop3_b32 v3, v35, v21, v3 bitop3:0xbe
  v_and_b32 v35, 0xffffff00, v35
  s_waitcnt vmcnt(3)
  v_bitop3_b32 v3, v36, v21, v3 bitop3:0xbe
  v_and_b32 v36, 0xffffff00, v36
  s_waitcnt vmcnt(2)
  v_bitop3_b32 v3, v37, v21, v3 bitop3:0xbe
  v_and_b32 v37, 0xffffff00, v37
  s_waitcnt vmcnt(1)
  v_bitop3_b32 v3, v38, v21, v3 bitop3:0xbe
  v_and_b32 v38, 0xffffff00, v38
  s_waitcnt vmcnt(0)
  v_bitop3_b32 v3, v39, v21, v3 bitop3:0xbe
  v_and_b32 v39, 0xffffff00, v39
  v_and_b32 v3, s37, v3
  v_cmp_ne_u32 vcc, 0, v3
  s_cbranch_vccz L_scok_8

  s_add_u32 s39, s39, 1
  s_cmp_lt_u32 s39, 20000
  s_cbranch_scc1 L_sc_7
L_scok_8:
  v_add_f32 v32, v32, v33
  v_add_f32 v34, v34, v35
  v_add_f32 v32, v32, v34
  v_add_f32 v36, v36, v37
  v_add_f32 v38, v38, v39
  v_add_f32 v36, v36, v38
  v_cvt_pk_bf16_f32 v36, 0, v36
  v_cvt_pk_bf16_f32 v32, 0, v32
  v_add_f32 v36, 1.0, v36
  v_cvt_pk_bf16_f32 v36, 0, v36
  v_mul_f32 v36, v25, v36
  v_cvt_pk_bf16_f32 v36, 0, v36

  v_add_f32 v33, v36, v32
  v_cvt_pk_bf16_f32 v33, v33, v33

  v_mov_b32 v34, v33
  s_nop 1
  v_mov_b32_dpp v34, v33 row_ror:8 row_mask:0xf bank_mask:0xc
  v_mov_b32_dpp v33, v33 row_ror:8 row_mask:0xf bank_mask:0x3

  s_nop 0
  v_and_b32_dpp v40, v34, v12 quad_perm:[0,0,0,0] row_mask:0xf bank_mask:0xf
  v_and_b32_dpp v41, v34, v13 quad_perm:[0,0,0,0] row_mask:0xf bank_mask:0xf
  v_and_b32_dpp v42, v34, v14 quad_perm:[0,0,0,0] row_mask:0xf bank_mask:0xf
  v_and_b32_dpp v43, v34, v15 quad_perm:[0,0,0,0] row_mask:0xf bank_mask:0xf
  s_nop 1
  v_mfma_f32_16x16x32_bf16 v[36:39], v[40:43], v[64:67], 0
  v_and_b32_dpp v44, v34, v12 quad_perm:[1,1,1,1] row_mask:0xf bank_mask:0xf
  v_and_b32_dpp v45, v34, v13 quad_perm:[1,1,1,1] row_mask:0xf bank_mask:0xf
  v_and_b32_dpp v46, v34, v14 quad_perm:[1,1,1,1] row_mask:0xf bank_mask:0xf
  v_and_b32_dpp v47, v34, v15 quad_perm:[1,1,1,1] row_mask:0xf bank_mask:0xf
  s_nop 1
  v_mfma_f32_16x16x32_bf16 v[36:39], v[44:47], v[68:71], v[36:39]
  v_and_b32_dpp v40, v34, v12 quad_perm:[2,2,2,2] row_mask:0xf bank_mask:0xf
  v_and_b32_dpp v41, v34, v13 quad_perm:[2,2,2,2] row_mask:0xf bank_mask:0xf
  v_and_b32_dpp v42, v34, v14 quad_perm:[2,2,2,2] row_mask:0xf bank_mask:0xf
  v_and_b32_dpp v43, v34, v15 quad_perm:[2,2,2,2] row_mask:0xf bank_mask:0xf
  s_nop 1
  v_mfma_f32_16x16x32_bf16 v[36:39], v[40:43], v[72:75], v[36:39]
  v_and_b32_dpp v44, v34, v12 quad_perm:[3,3,3,3] row_mask:0xf bank_mask:0xf
  v_and_b32_dpp v45, v34, v13 quad_perm:[3,3,3,3] row_mask:0xf bank_mask:0xf
  v_and_b32_dpp v46, v34, v14 quad_perm:[3,3,3,3] row_mask:0xf bank_mask:0xf
  v_and_b32_dpp v47, v34, v15 quad_perm:[3,3,3,3] row_mask:0xf bank_mask:0xf
  s_nop 1
  v_mfma_f32_16x16x32_bf16 v[36:39], v[44:47], v[76:79], v[36:39]
  v_and_b32_dpp v40, v33, v12 quad_perm:[0,0,0,0] row_mask:0xf bank_mask:0xf
  v_and_b32_dpp v41, v33, v13 quad_perm:[0,0,0,0] row_mask:0xf bank_mask:0xf
  v_and_b32_dpp v42, v33, v14 quad_perm:[0,0,0,0] row_mask:0xf bank_mask:0xf
  v_and_b32_dpp v43, v33, v15 quad_perm:[0,0,0,0] row_mask:0xf bank_mask:0xf
  s_nop 1
  v_mfma_f32_16x16x32_bf16 v[36:39], v[40:43], v[80:83], v[36:39]
  v_and_b32_dpp v44, v33, v12 quad_perm:[1,1,1,1] row_mask:0xf bank_mask:0xf
  v_and_b32_dpp v45, v33, v13 quad_perm:[1,1,1,1] row_mask:0xf bank_mask:0xf
  v_and_b32_dpp v46, v33, v14 quad_perm:[1,1,1,1] row_mask:0xf bank_mask:0xf
  v_and_b32_dpp v47, v33, v15 quad_perm:[1,1,1,1] row_mask:0xf bank_mask:0xf
  s_nop 1
  v_mfma_f32_16x16x32_bf16 v[36:39], v[44:47], v[84:87], v[36:39]
  v_and_b32_dpp v40, v33, v12 quad_perm:[2,2,2,2] row_mask:0xf bank_mask:0xf
  v_and_b32_dpp v41, v33, v13 quad_perm:[2,2,2,2] row_mask:0xf bank_mask:0xf
  v_and_b32_dpp v42, v33, v14 quad_perm:[2,2,2,2] row_mask:0xf bank_mask:0xf
  v_and_b32_dpp v43, v33, v15 quad_perm:[2,2,2,2] row_mask:0xf bank_mask:0xf
  s_nop 1
  v_mfma_f32_16x16x32_bf16 v[36:39], v[40:43], v[88:91], v[36:39]
  s_nop 7
  v_permlane16_swap_b32 v36, v37
  v_permlane16_swap_b32 v38, v39
  s_nop 0
  v_add_f32_dpp v8, v37, v36 row_ror:8 row_mask:0xf bank_mask:0x3
  s_nop 1
  v_add_f32_dpp v8, v38, v39 row_ror:8 row_mask:0xf bank_mask:0xc

  ds_write_b32 v10, v8
  s_waitcnt lgkmcnt(0)
  s_barrier

  ds_read_b64 v[40:41], v6 offset:0
  ds_read_b64 v[42:43], v6 offset:256
  ds_read_b64 v[44:45], v6 offset:512
  ds_read_b64 v[46:47], v6 offset:768
  ds_read_b64 v[48:49], v6 offset:1024
  ds_read_b64 v[50:51], v6 offset:1280
  ds_read_b64 v[52:53], v6 offset:1536
  ds_read_b64 v[54:55], v6 offset:1792

  s_waitcnt lgkmcnt(6)
  v_pk_add_f32 v[40:41], v[40:41], v[42:43]
  s_waitcnt lgkmcnt(4)
  v_pk_add_f32 v[44:45], v[44:45], v[46:47]
  s_waitcnt lgkmcnt(2)
  v_pk_add_f32 v[48:49], v[48:49], v[50:51]
  v_pk_add_f32 v[40:41], v[40:41], v[44:45]
  s_waitcnt lgkmcnt(0)
  v_pk_add_f32 v[52:53], v[52:53], v[54:55]
  v_pk_add_f32 v[40:41], v[40:41], v[48:49]
  v_pk_add_f32 v[40:41], v[40:41], v[52:53]
  v_cvt_pk_bf16_f32 v40, v40, v41
  s_nop 1
  v_mov_b32_dpp v56, v40 quad_perm:[0,0,0,0] row_mask:0xf bank_mask:0xf
  v_mov_b32_dpp v57, v40 quad_perm:[1,1,1,1] row_mask:0xf bank_mask:0xf
  v_mov_b32_dpp v58, v40 quad_perm:[2,2,2,2] row_mask:0xf bank_mask:0xf

  buffer_store_dwordx4 v[56:59], v9, s[32:35], s54 offen
  buffer_store_dwordx4 v[56:59], v9, s[32:35], s53 offen sc1

  s_barrier
  s_cmp_lg_u32 s56, 7
  s_cbranch_scc1 L_O
L_Q_pubd:
  s_mov_b32 s48, s24
  s_mov_b32 s49, s25
  s_mov_b32 s50, 2408448
  s_mov_b32 s51, 0x20000
  s_barrier

  s_lshr_b32 s3, s56, 1
  s_lshl_b32 s57, s3, 3
  s_add_u32 s57, s57, s55
  s_and_b32 s58, s55, 3
  s_add_u32 s58, s58, 24
  s_cmp_eq_u32 s3, 3
  s_cselect_b32 s57, s58, s57

  s_lshl_b32 s57, s57, 7
  s_mul_i32 s3, s38, 200704
  s_add_u32 s57, s57, s3
  s_bitcmp1_b32 s56, 0
  s_cselect_b32 s48, s18, s16
  s_cselect_b32 s49, s19, s17
  s_mov_b32 s50, 1605632

  v_lshrrev_b32 v2, 3, v0
  v_mul_u32_u24 v2, 3584, v2
  v_lshl_add_u32 v2, v26, 4, v2

  buffer_load_dwordx4 v[80:83], v2, s[48:51], s57 offen
  s_add_u32 s57, s57, 28672
  buffer_load_dwordx4 v[80:83], v2, s[48:51], s57 offen
  s_add_u32 s57, s57, 28672
  buffer_load_dwordx4 v[80:83], v2, s[48:51], s57 offen
  s_add_u32 s57, s57, 28672
  buffer_load_dwordx4 v[80:83], v2, s[48:51], s57 offen
  s_add_u32 s57, s57, 28672
  buffer_load_dwordx4 v[80:83], v2, s[48:51], s57 offen
  s_add_u32 s57, s57, 28672
  buffer_load_dwordx4 v[80:83], v2, s[48:51], s57 offen
  s_add_u32 s57, s57, 28672
  buffer_load_dwordx4 v[80:83], v2, s[48:51], s57 offen
L_Q_done:
  s_waitcnt vmcnt(0)
  s_endpgm
L_O:
  s_add_u32 m0, s68, 0
  s_nop 0
  buffer_load_dwordx4 v100, s[60:63], s66 offen nt lds
  s_add_u32 s66, s66, 3584
  s_add_u32 m0, s68, 1024
  s_nop 0
  buffer_load_dwordx4 v101, s[60:63], s66 offen nt lds
  s_add_u32 s66, s66, 3584
  s_add_u32 m0, s68, 2048
  s_nop 0
  buffer_load_dwordx4 v100, s[60:63], s66 offen nt lds
  s_add_u32 s66, s66, 3584
  s_add_u32 m0, s68, 3072
  s_nop 0
  buffer_load_dwordx4 v101, s[60:63], s66 offen nt lds
  s_add_u32 s66, s66, 17920
  s_add_u32 m0, s68, 4096
  s_nop 0
  buffer_load_dwordx4 v100, s[60:63], s66 offen nt lds
  s_add_u32 s66, s66, 3584
  s_add_u32 m0, s68, 5120
  s_nop 0
  buffer_load_dwordx4 v101, s[60:63], s66 offen nt lds
  s_add_u32 s66, s66, 3584
  s_add_u32 m0, s68, 6144
  s_nop 0
  buffer_load_dwordx4 v100, s[60:63], s66 offen nt lds
  s_add_u32 s66, s66, 3584
  s_add_u32 m0, s68, 7168
  s_nop 0
  buffer_load_dwordx4 v101, s[60:63], s66 offen nt lds
  buffer_load_dwordx4 v[56:59], v107, s[32:35], s67 offen sc1
  s_mov_b32 s39, 0
  s_waitcnt vmcnt(1)
  ds_read_b64_tr_b16 v[112:113], v102 offset:0
  ds_read_b64_tr_b16 v[114:115], v102 offset:512
  ds_read_b64_tr_b16 v[116:117], v103 offset:0
  ds_read_b64_tr_b16 v[118:119], v103 offset:512
  ds_read_b64_tr_b16 v[120:121], v104 offset:0
  ds_read_b64_tr_b16 v[122:123], v104 offset:512
  ds_read_b64_tr_b16 v[124:125], v105 offset:0
  ds_read_b64_tr_b16 v[126:127], v105 offset:512
  ds_read_b64_tr_b16 v[128:129], v102 offset:4096
  ds_read_b64_tr_b16 v[130:131], v102 offset:4608
  ds_read_b64_tr_b16 v[132:133], v103 offset:4096
  ds_read_b64_tr_b16 v[134:135], v103 offset:4608
  ds_read_b64_tr_b16 v[136:137], v104 offset:4096
  ds_read_b64_tr_b16 v[138:139], v104 offset:4608
  ds_read_b64_tr_b16 v[140:141], v105 offset:4096
  ds_read_b64_tr_b16 v[142:143], v105 offset:4608

L_O_mlchk:
  s_waitcnt vmcnt(0)
  v_bitop3_b32 v58, v56, v58, s36 bitop3:0x96
  v_bitop3_b32 v59, v57, v59, s36 bitop3:0x96
  v_or_b32 v58, v58, v59
  v_cmp_ne_u32 vcc, 0, v58
  s_cbranch_vccnz L_O_mlslow
L_O_mlok:
  s_mov_b64 exec, -1
  buffer_load_dwordx4 v[64:67], v106, s[32:35], s64 offen offset:0 sc1
  buffer_load_dwordx4 v[68:71], v106, s[32:35], s64 offen offset:2048 sc1
  buffer_load_dwordx4 v[72:75], v106, s[32:35], s64 offen offset:1024 sc1
  buffer_load_dwordx4 v[76:79], v106, s[32:35], s64 offen offset:3072 sc1

  v_max_f32_dpp v16, v56, v56 quad_perm:[1,0,3,2] row_mask:0xf bank_mask:0xf
  s_nop 1
  v_max_f32_dpp v16, v16, v16 quad_perm:[2,3,0,1] row_mask:0xf bank_mask:0xf
  v_mov_b32 v17, v16
  s_nop 1
  v_permlane16_swap_b32 v16, v17
  v_max_f32 v16, v16, v17
  v_mov_b32 v17, v16
  s_nop 1
  v_permlane32_swap_b32 v16, v17
  v_max_f32 v16, v16, v17
  v_sub_f32 v16, v56, v16
  v_exp_f32 v16, v16
  s_nop 0
  v_mul_f32 v17, v16, v57
  s_nop 1
  v_add_f32_dpp v17, v17, v17 quad_perm:[1,0,3,2] row_mask:0xf bank_mask:0xf
  s_nop 1
  v_add_f32_dpp v17, v17, v17 quad_perm:[2,3,0,1] row_mask:0xf bank_mask:0xf
  v_mov_b32 v18, v17
  s_nop 1
  v_permlane16_swap_b32 v17, v18
  v_add_f32 v17, v17, v18
  v_mov_b32 v18, v17
  s_nop 1
  v_permlane32_swap_b32 v17, v18
  v_add_f32 v17, v17, v18
  v_rcp_f32 v17, v17
  s_nop 1
  v_mul_f32_dpp v12, v16, v17 quad_perm:[0,0,0,0] row_mask:0xf bank_mask:0xf
  v_mul_f32_dpp v13, v16, v17 quad_perm:[1,1,1,1] row_mask:0xf bank_mask:0xf
  v_mul_f32_dpp v14, v16, v17 quad_perm:[2,2,2,2] row_mask:0xf bank_mask:0xf
  v_mul_f32_dpp v15, v16, v17 quad_perm:[3,3,3,3] row_mask:0xf bank_mask:0xf
L_O_ochk:
  s_waitcnt vmcnt(3) lgkmcnt(0)
  v_mfma_f32_16x16x32_bf16 v[80:83], v[64:67], v[112:115], 0
  v_mfma_f32_16x16x32_bf16 v[84:87], v[64:67], v[116:119], 0
  v_mfma_f32_16x16x32_bf16 v[88:91], v[64:67], v[120:123], 0
  v_mfma_f32_16x16x32_bf16 v[92:95], v[64:67], v[124:127], 0
  s_waitcnt vmcnt(2)
  v_mfma_f32_16x16x32_bf16 v[80:83], v[68:71], v[128:131], v[80:83]
  v_mfma_f32_16x16x32_bf16 v[84:87], v[68:71], v[132:135], v[84:87]
  v_mfma_f32_16x16x32_bf16 v[88:91], v[68:71], v[136:139], v[88:91]
  v_mfma_f32_16x16x32_bf16 v[92:95], v[68:71], v[140:143], v[92:95]
  s_waitcnt vmcnt(1)
  v_bitop3_b32 v72, v64, v72, s36 bitop3:0x96
  v_bitop3_b32 v73, v65, v73, s36 bitop3:0x96
  v_bitop3_b32 v74, v66, v74, s36 bitop3:0x96
  v_bitop3_b32 v75, v67, v75, s36 bitop3:0x96
  v_or3_b32 v72, v72, v73, v74
  s_waitcnt vmcnt(0)
  v_bitop3_b32 v76, v68, v76, s36 bitop3:0x96
  v_bitop3_b32 v77, v69, v77, s36 bitop3:0x96
  v_bitop3_b32 v78, v70, v78, s36 bitop3:0x96
  v_bitop3_b32 v79, v71, v79, s36 bitop3:0x96

  v_or3_b32 v72, v72, v75, v76
  v_or3_b32 v77, v77, v78, v79
  v_or_b32 v72, v72, v77
  v_cmp_ne_u32 vcc, 0, v72
  s_cbranch_vccnz L_O_oslow
L_O_ook:
  s_mov_b64 exec, -1
  v_pk_mul_f32 v[80:81], v[80:81], v[12:13]
  v_pk_mul_f32 v[84:85], v[84:85], v[12:13]
  v_pk_mul_f32 v[88:89], v[88:89], v[12:13]
  v_pk_mul_f32 v[92:93], v[92:93], v[12:13]
  v_pk_fma_f32 v[80:81], v[82:83], v[14:15], v[80:81]
  v_pk_fma_f32 v[84:85], v[86:87], v[14:15], v[84:85]
  v_pk_fma_f32 v[88:89], v[90:91], v[14:15], v[88:89]
  v_pk_fma_f32 v[92:93], v[94:95], v[14:15], v[92:93]

  v_permlane16_swap_b32 v80, v84
  v_permlane16_swap_b32 v81, v85
  v_permlane16_swap_b32 v88, v92
  v_permlane16_swap_b32 v89, v93
  v_pk_add_f32 v[80:81], v[80:81], v[84:85]
  v_pk_add_f32 v[88:89], v[88:89], v[92:93]
  v_add_f32 v80, v80, v81
  v_add_f32 v88, v88, v89
  s_nop 1
  v_permlane32_swap_b32 v80, v88
  v_add_f32 v80, v80, v88
  ds_write_b32 v108, v80 offset:4096
  s_waitcnt lgkmcnt(0)
  s_barrier
  ds_read2st64_b32 v[64:65], v11 offset0:16 offset1:17
  ds_read2st64_b32 v[66:67], v11 offset0:18 offset1:19
  ds_read2st64_b32 v[68:69], v11 offset0:20 offset1:21
  ds_read2st64_b32 v[70:71], v11 offset0:22 offset1:23

  s_waitcnt lgkmcnt(2)
  v_pk_add_f32 v[64:65], v[64:65], v[66:67]
  s_waitcnt lgkmcnt(0)
  v_pk_add_f32 v[68:69], v[68:69], v[70:71]
  v_pk_add_f32 v[64:65], v[64:65], v[68:69]
  v_add_f32 v64, v64, v65
  s_nop 1
  v_mov_b32_dpp v65, v64 quad_perm:[1,1,1,1] row_mask:0xf bank_mask:0xf
  v_mov_b32_dpp v66, v64 quad_perm:[2,2,2,2] row_mask:0xf bank_mask:0xf
  v_mov_b32_dpp v67, v64 quad_perm:[3,3,3,3] row_mask:0xf bank_mask:0xf
  v_bfi_b32 v64, s37, v110, v64
  s_mov_b64 exec, s[70:71]
  buffer_store_dwordx4 v[64:67], v11, s[32:35], s65 offen sc1
  s_mov_b64 exec, -1
  s_endpgm

L_O_mlslow:
  s_mov_b64 exec, vcc
  s_add_u32 s39, s39, 1
  s_cmp_lg_u32 s39, 24
  s_cbranch_scc1 L_O_mlre
  s_add_u32 s64, s64, 262144
  s_add_u32 s67, s67, 4096
L_O_mlre:
  s_cmp_ge_u32 s39, 20000
  s_cbranch_scc1 L_O_mlok
  buffer_load_dwordx4 v[56:59], v107, s[32:35], s67 offen sc1
  s_branch L_O_mlchk

L_O_oslow:
  s_mov_b64 exec, vcc
  s_add_u32 s39, s39, 1
  s_cmp_lg_u32 s39, 24
  s_cbranch_scc1 L_O_ore
  s_add_u32 s64, s64, 262144
  s_add_u32 s67, s67, 4096
L_O_ore:
  s_cmp_ge_u32 s39, 20000
  s_cbranch_scc1 L_O_ook
  buffer_load_dwordx4 v[64:67], v106, s[32:35], s64 offen offset:0 sc1
  buffer_load_dwordx4 v[68:71], v106, s[32:35], s64 offen offset:2048 sc1
  buffer_load_dwordx4 v[72:75], v106, s[32:35], s64 offen offset:1024 sc1
  buffer_load_dwordx4 v[76:79], v106, s[32:35], s64 offen offset:3072 sc1
  s_branch L_O_ochk
L_end:
  s_endpgm
.section .rodata,"a"
.p2align 6
.amdhsa_kernel adaLN_cond__sliding_block_cached__geglu_ffn__decode_kernel
  .amdhsa_next_free_vgpr 168
  .amdhsa_next_free_sgpr 102
  .amdhsa_accum_offset 168
  .amdhsa_group_segment_fixed_size 0
  .amdhsa_kernarg_size 112
  .amdhsa_user_sgpr_count 2
  .amdhsa_user_sgpr_kernarg_segment_ptr 1
  .amdhsa_system_sgpr_workgroup_id_x 1
  .amdhsa_float_denorm_mode_32 3
  .amdhsa_float_denorm_mode_16_64 3
.end_amdhsa_kernel
.text
```
